```python
import torch

def _softmax(x, axis=-1):
    return torch.softmax(x, dim=axis)
def _gelu(x):
    return torch.nn.functional.gelu(x, approximate="tanh")
def _silu(x):
    return torch.nn.functional.silu(x)
def _sigmoid(x):
    return torch.sigmoid(x)
def _layernorm(x, axis=-1, eps=1e-5):
    m = x.mean(dim=axis, keepdim=True)
    v = x.var(dim=axis, keepdim=True, unbiased=False)
    return (x - m) / torch.sqrt(v + eps)
def _scatter_add(tgt, idx, src, axis=0):
    return tgt.clone().index_add_(axis, idx, src)
def _segment_sum(src, seg, n):
    out = torch.zeros((n,) + src.shape[1:], dtype=src.dtype)
    return out.index_add_(0, seg, src)
def _pad(x, pw):
    flat = tuple(v for pair in reversed(pw) for v in pair)
    return torch.nn.functional.pad(x, flat)

kernel_name = 'standalone__cross_network_dcn_v2__recsys'

def setup_inputs():

    _w = (lambda a: (lambda t: t.to(torch.bfloat16) if t.is_floating_point() else t)(torch.as_tensor(a)))
    B, F, D, L = 16384, 100, 32, 6
    Din = min(F * D, 512)
    R = max(Din // 4, 2)
    sc = Din ** -0.5
    return {
        "x0": _w((lambda *s: torch.randn(*s, dtype=torch.bfloat16) * 0.05)(B, Din)),
        "U":  _w((lambda *s: torch.randn(*s, dtype=torch.bfloat16) * 1.6)(L, Din, R) * sc),
        "V":  _w((lambda *s: torch.randn(*s, dtype=torch.bfloat16) * 1.6)(L, R, Din) * sc),
        "bs": _w((lambda *s: torch.randn(*s, dtype=torch.bfloat16) * 0.05)(L, Din)),
    }

def reference(x0, U, V, bs):
    x = x0
    for l in range(U.shape[0]):
        h = torch.einsum('rd,bd->br', V[l], x)
        h = torch.einsum('dr,br->bd', U[l], h)
        x = x0 * (h + bs[l]) + x
    return x
```

```asm
; @launch grid=(256,1,1) block=(256,1,1) lds=159744
.amdgcn_target "amdgcn-amd-amdhsa--gfx950"
.text
.globl standalone__cross_network_dcn_v2__recsys_kernel
.p2align 8
.type standalone__cross_network_dcn_v2__recsys_kernel,@function
standalone__cross_network_dcn_v2__recsys_kernel:
    s_cmp_ge_u32 s2, 256
    s_cbranch_scc1 L_done
    s_load_dwordx4 s[32:35], s[0:1], 0
    s_load_dwordx4 s[96:99], s[0:1], 16
    s_load_dwordx4 s[44:47], s[0:1], 32
    s_load_dwordx2 s[38:39], s[0:1], 48
    v_lshrrev_b32 v200, 6, v0
    v_and_b32 v201, 63, v0
    v_readfirstlane_b32 s24, v200
    v_lshlrev_b32 v254, 4, v201
    v_lshlrev_b32 v223, 2, v201
    v_lshrrev_b32 v202, 3, v201
    v_lshrrev_b32 v203, 4, v201
    v_and_b32 v204, 1, v202
    v_lshlrev_b32 v204, 2, v204
    v_or_b32 v203, v203, v204
    v_and_b32 v204, 7, v201
    v_xor_b32 v203, v203, v204
    v_lshlrev_b32 v203, 4, v203
    v_lshlrev_b32 v202, 10, v202
    v_add_u32 v216, v202, v203
    v_xor_b32 v217, 64, v216
    v_lshrrev_b32 v202, 5, v201
    v_lshlrev_b32 v202, 3, v202
    v_bfe_u32 v204, v201, 3, 2
    v_add_u32 v202, v202, v204
    v_lshl_add_u32 v218, v202, 10, v203
    v_xor_b32 v219, 64, v218
    v_lshl_add_u32 v220, v202, 8, v203
    v_xor_b32 v221, 64, v220
    v_and_b32 v200, 31, v201
    v_and_b32 v206, 19, v200
    v_and_b32 v204, 4, v200
    v_lshlrev_b32 v204, 1, v204
    v_or_b32 v206, v206, v204
    v_and_b32 v204, 8, v200
    v_lshrrev_b32 v204, 1, v204
    v_or_b32 v206, v206, v204
    v_lshrrev_b32 v202, 5, v201
    v_lshlrev_b32 v207, 4, v202
    s_lshl_b32 s25, s2, 16
    s_lshl_b32 s26, s24, 8
    s_add_u32 s25, s25, s26
    s_lshl_b32 s28, s24, 14
    s_lshl_b32 s29, s24, 15
    s_lshl_b32 s20, s24, 16
    s_add_u32 s20, s20, 262144
    s_waitcnt lgkmcnt(0)
    s_mov_b32 s8, s32
    s_and_b32 s9, s33, 0xffff
    s_mov_b32 s10, 16777216
    s_mov_b32 s11, 0x00020000
    s_mov_b32 s84, s34
    s_and_b32 s85, s35, 0xffff
    s_mov_b32 s86, 786432
    s_mov_b32 s87, 0x00020000
    s_mov_b32 s88, s96
    s_and_b32 s89, s97, 0xffff
    s_mov_b32 s90, 786432
    s_mov_b32 s91, 0x00020000
    s_mov_b32 s16, s98
    s_and_b32 s17, s99, 0xffff
    s_mov_b32 s18, 6144
    s_mov_b32 s19, 0x00020000
    s_mov_b32 s12, s44
    s_and_b32 s13, s45, 0xffff
    s_mov_b32 s14, 16777216
    s_mov_b32 s15, 0x00020000
    s_mov_b32 s92, s46
    s_and_b32 s93, s47, 0xffff
    s_mov_b32 s94, 256
    s_mov_b32 s95, 0x00020000
    s_mov_b32 s4, s38
    s_and_b32 s5, s39, 0xffff
    s_mov_b32 s6, 1572864
    s_mov_b32 s7, 0x00020000
    s_lshr_b32 s26, s2, 3
    s_lshl_b32 s26, s26, 12
    s_lshl_b32 s27, s24, 10
    s_add_u32 s26, s26, s27
    buffer_load_dwordx4 a[128:131], v254, s[88:91], s26 offen
    buffer_load_dwordx4 a[132:135], v254, s[84:87], s26 offen
    s_lshr_b32 s3, s2, 3
    s_lshl_b32 s3, s3, 2
    s_and_b32 s26, s2, 3
    s_or_b32 s3, s3, s26
    s_and_b32 s26, s2, 4
    s_lshl_b32 s26, s26, 6
    s_or_b32 s3, s3, s26
    s_cmp_ge_u32 s3, 64
    s_cbranch_scc1 L_nogather
    s_lshr_b32 s30, s3, 4
    s_lshl_b32 s30, s30, 15
    s_and_b32 s23, s3, 15
    s_add_u32 s31, s24, 1
    s_lshl_b32 s31, s31, 17
    s_add_u32 s31, s31, s30
    s_add_u32 s30, s30, 655360
    s_lshl_b32 s40, s24, 12
    s_add_u32 s40, s40, 131072
    s_and_b32 s41, s3, 3
    s_cmp_ge_u32 s23, 8
    s_cbranch_scc1 L_gu
    s_lshl_b32 s26, s23, 7
    s_add_u32 s31, s31, s26
    s_add_u32 s30, s30, s26
    s_add_u32 s26, s40, 0
    s_mov_b32 m0, s26
    s_add_u32 s27, s31, 0
    buffer_load_dwordx4 v218, s[88:91], s27 offen nt lds
    s_add_u32 s26, s40, 1024
    s_mov_b32 m0, s26
    s_add_u32 s27, s31, 4096
    buffer_load_dwordx4 v218, s[88:91], s27 offen nt lds
    s_add_u32 s26, s40, 2048
    s_mov_b32 m0, s26
    s_add_u32 s27, s31, 16384
    buffer_load_dwordx4 v219, s[88:91], s27 offen nt lds
    s_add_u32 s26, s40, 3072
    s_mov_b32 m0, s26
    s_add_u32 s27, s31, 20480
    buffer_load_dwordx4 v219, s[88:91], s27 offen nt lds
    s_cmp_lg_u32 s41, s24
    s_cbranch_scc1 L_nogather
    s_mov_b32 m0, 155648
    s_add_u32 s27, s30, 0
    buffer_load_dwordx4 v218, s[88:91], s27 offen nt lds
    s_mov_b32 m0, 156672
    s_add_u32 s27, s30, 4096
    buffer_load_dwordx4 v218, s[88:91], s27 offen nt lds
    s_mov_b32 m0, 157696
    s_add_u32 s27, s30, 16384
    buffer_load_dwordx4 v219, s[88:91], s27 offen nt lds
    s_mov_b32 m0, 158720
    s_add_u32 s27, s30, 20480
    buffer_load_dwordx4 v219, s[88:91], s27 offen nt lds
    s_branch L_nogather
L_gu:
    s_sub_u32 s26, s23, 8
    s_lshr_b32 s26, s26, 1
    s_lshl_b32 s26, s26, 13
    s_and_b32 s27, s23, 1
    s_lshl_b32 s27, s27, 7
    s_add_u32 s26, s26, s27
    s_add_u32 s31, s31, s26
    s_add_u32 s30, s30, s26
    s_add_u32 s26, s40, 0
    s_mov_b32 m0, s26
    s_add_u32 s27, s31, 0
    buffer_load_dwordx4 v220, s[84:87], s27 offen nt lds
    s_add_u32 s26, s40, 1024
    s_mov_b32 m0, s26
    s_add_u32 s27, s31, 1024
    buffer_load_dwordx4 v220, s[84:87], s27 offen nt lds
    s_add_u32 s26, s40, 2048
    s_mov_b32 m0, s26
    s_add_u32 s27, s31, 4096
    buffer_load_dwordx4 v221, s[84:87], s27 offen nt lds
    s_add_u32 s26, s40, 3072
    s_mov_b32 m0, s26
    s_add_u32 s27, s31, 5120
    buffer_load_dwordx4 v221, s[84:87], s27 offen nt lds
    s_cmp_lg_u32 s41, s24
    s_cbranch_scc1 L_nogather
    s_mov_b32 m0, 155648
    s_add_u32 s27, s30, 0
    buffer_load_dwordx4 v220, s[84:87], s27 offen nt lds
    s_mov_b32 m0, 156672
    s_add_u32 s27, s30, 1024
    buffer_load_dwordx4 v220, s[84:87], s27 offen nt lds
    s_mov_b32 m0, 157696
    s_add_u32 s27, s30, 4096
    buffer_load_dwordx4 v221, s[84:87], s27 offen nt lds
    s_mov_b32 m0, 158720
    s_add_u32 s27, s30, 5120
    buffer_load_dwordx4 v221, s[84:87], s27 offen nt lds
L_nogather:
    s_add_u32 m0, s28, 0
    s_add_u32 s43, s29, 0
    buffer_load_dwordx4 v218, s[88:91], s43 offen lds
    s_addk_i32 m0, 1024
    s_addk_i32 s43, 4096
    buffer_load_dwordx4 v218, s[88:91], s43 offen lds
    s_addk_i32 m0, 1024
    s_addk_i32 s43, 12288
    buffer_load_dwordx4 v219, s[88:91], s43 offen lds
    s_addk_i32 m0, 1024
    s_addk_i32 s43, 4096
    buffer_load_dwordx4 v219, s[88:91], s43 offen lds
    s_addk_i32 m0, 5120
    s_addk_i32 s43, -20352
    buffer_load_dwordx4 v218, s[88:91], s43 offen lds
    s_addk_i32 m0, 1024
    s_addk_i32 s43, 4096
    buffer_load_dwordx4 v218, s[88:91], s43 offen lds
    s_addk_i32 m0, 1024
    s_addk_i32 s43, 12288
    buffer_load_dwordx4 v219, s[88:91], s43 offen lds
    s_addk_i32 m0, 1024
    s_addk_i32 s43, 4096
    buffer_load_dwordx4 v219, s[88:91], s43 offen lds
    s_add_u32 m0, s28, 65536
    s_addk_i32 s43, -20352
    buffer_load_dwordx4 v218, s[88:91], s43 offen lds
    s_addk_i32 m0, 1024
    s_addk_i32 s43, 4096
    buffer_load_dwordx4 v218, s[88:91], s43 offen lds
    s_addk_i32 m0, 1024
    s_addk_i32 s43, 12288
    buffer_load_dwordx4 v219, s[88:91], s43 offen lds
    s_addk_i32 m0, 1024
    s_addk_i32 s43, 4096
    buffer_load_dwordx4 v219, s[88:91], s43 offen lds
    s_addk_i32 m0, 5120
    s_addk_i32 s43, -20352
    buffer_load_dwordx4 v218, s[88:91], s43 offen lds
    s_addk_i32 m0, 1024
    s_addk_i32 s43, 4096
    buffer_load_dwordx4 v218, s[88:91], s43 offen lds
    s_addk_i32 m0, 1024
    s_addk_i32 s43, 12288
    buffer_load_dwordx4 v219, s[88:91], s43 offen lds
    s_addk_i32 m0, 1024
    s_addk_i32 s43, 4096
    buffer_load_dwordx4 v219, s[88:91], s43 offen lds
    s_add_u32 m0, s28, 4096
    s_add_u32 s43, s25, 0
    buffer_load_dwordx4 v216, s[8:11], s43 offen nt lds
    s_addk_i32 m0, 1024
    s_addk_i32 s43, 8192
    buffer_load_dwordx4 v216, s[8:11], s43 offen nt lds
    s_addk_i32 m0, 1024
    s_addk_i32 s43, 8192
    buffer_load_dwordx4 v217, s[8:11], s43 offen nt lds
    s_addk_i32 m0, 1024
    s_addk_i32 s43, 8192
    buffer_load_dwordx4 v217, s[8:11], s43 offen nt lds
    s_addk_i32 m0, 5120
    s_addk_i32 s43, -24448
    buffer_load_dwordx4 v216, s[8:11], s43 offen nt lds
    s_addk_i32 m0, 1024
    s_addk_i32 s43, 8192
    buffer_load_dwordx4 v216, s[8:11], s43 offen nt lds
    s_addk_i32 m0, 1024
    s_addk_i32 s43, 8192
    buffer_load_dwordx4 v217, s[8:11], s43 offen nt lds
    s_addk_i32 m0, 1024
    s_addk_i32 s43, 8192
    buffer_load_dwordx4 v217, s[8:11], s43 offen nt lds
    v_lshrrev_b32 v203, 1, v200
    v_and_b32 v203, 3, v203
    v_lshrrev_b32 v204, 4, v200
    v_xor_b32 v204, v204, v200
    v_and_b32 v204, 1, v204
    v_lshlrev_b32 v204, 2, v204
    v_or_b32 v203, v203, v204
    v_xor_b32 v203, v203, v202
    v_lshlrev_b32 v204, 7, v200
    v_xor_b32 v205, 0, v203
    v_lshlrev_b32 v205, 4, v205
    v_add_u32 v205, v205, v204
    v_add_u32 v236, 4096, v205
    v_add_u32 v240, 0x11000, v205
    v_add_u32 v244, s28, v205
    v_add_u32 v248, 0x10000, v244
    v_xor_b32 v205, 2, v203
    v_lshlrev_b32 v205, 4, v205
    v_add_u32 v205, v205, v204
    v_add_u32 v237, 4096, v205
    v_add_u32 v241, 0x11000, v205
    v_add_u32 v245, s28, v205
    v_add_u32 v249, 0x10000, v245
    v_xor_b32 v205, 4, v203
    v_lshlrev_b32 v205, 4, v205
    v_add_u32 v205, v205, v204
    v_add_u32 v238, 4096, v205
    v_add_u32 v242, 0x11000, v205
    v_add_u32 v246, s28, v205
    v_add_u32 v250, 0x10000, v246
    v_xor_b32 v205, 6, v203
    v_lshlrev_b32 v205, 4, v205
    v_add_u32 v205, v205, v204
    v_add_u32 v239, 4096, v205
    v_add_u32 v243, 0x11000, v205
    v_add_u32 v247, s28, v205
    v_add_u32 v251, 0x10000, v247
    s_waitcnt vmcnt(20)
    ds_read_b128 a[0:3], v244 offset:0
    ds_read_b128 a[4:7], v245 offset:0
    ds_read_b128 a[32:35], v246 offset:0
    ds_read_b128 a[36:39], v247 offset:0
    s_waitcnt vmcnt(16)
    ds_read_b128 a[64:67], v244 offset:8192
    ds_read_b128 a[68:71], v245 offset:8192
    ds_read_b128 a[96:99], v246 offset:8192
    ds_read_b128 a[100:103], v247 offset:8192
    s_waitcnt vmcnt(12)
    ds_read_b128 a[8:11], v248 offset:0
    ds_read_b128 a[12:15], v249 offset:0
    ds_read_b128 a[40:43], v250 offset:0
    ds_read_b128 a[44:47], v251 offset:0
    s_waitcnt vmcnt(8)
    ds_read_b128 a[72:75], v248 offset:8192
    ds_read_b128 a[76:79], v249 offset:8192
    ds_read_b128 a[104:107], v250 offset:8192
    ds_read_b128 a[108:111], v251 offset:8192
    s_cmp_ge_u32 s3, 64
    s_cbranch_scc1 L_nostore
    s_waitcnt vmcnt(24)
    s_sub_u32 s26, s40, 4096
    v_add_u32 v205, s26, v236
    ds_read_b128 v[144:147], v205
    v_add_u32 v205, s26, v237
    ds_read_b128 v[148:151], v205
    v_add_u32 v205, s26, v238
    ds_read_b128 v[152:155], v205
    v_add_u32 v205, s26, v239
    ds_read_b128 v[156:159], v205
    v_add_u32 v205, 151552, v236
    ds_read_b128 v[128:131], v205
    v_add_u32 v205, 151552, v237
    ds_read_b128 v[132:135], v205
    v_add_u32 v205, 151552, v238
    ds_read_b128 v[136:139], v205
    v_add_u32 v205, 151552, v239
    ds_read_b128 v[140:143], v205
    s_and_b32 s26, s23, 1
    s_lshl_b32 s26, s26, 4
    s_and_b32 s27, s23, 6
    s_add_u32 s26, s26, s27
    s_lshl_b32 s27, s23, 2
    s_cmp_ge_u32 s23, 8
    s_cselect_b32 s26, s27, s26
    s_cselect_b32 s42, 2, 8
    s_lshl_b32 s42, s42, 10
    s_lshl_b32 s26, s26, 10
    s_lshr_b32 s27, s3, 4
    s_lshl_b32 s27, s27, 16
    s_add_u32 s26, s26, s27
    s_add_u32 s27, s24, 1
    s_lshl_b32 s27, s27, 18
    s_add_u32 s31, s26, s27
    s_add_u32 s30, s26, 1310720
    s_waitcnt lgkmcnt(0)
    buffer_store_dwordx4 v[144:147], v254, s[4:7], s31 offen offset:0 sc1
    buffer_store_dwordx4 v[148:151], v254, s[4:7], s31 offen offset:1024 sc1
    s_add_u32 s31, s31, s42
    buffer_store_dwordx4 v[152:155], v254, s[4:7], s31 offen offset:0 sc1
    buffer_store_dwordx4 v[156:159], v254, s[4:7], s31 offen offset:1024 sc1
    s_cmp_lg_u32 s41, s24
    s_cbranch_scc1 L_nostore
    buffer_store_dwordx4 v[128:131], v254, s[4:7], s30 offen offset:0 sc1
    buffer_store_dwordx4 v[132:135], v254, s[4:7], s30 offen offset:1024 sc1
    s_add_u32 s30, s30, s42
    buffer_store_dwordx4 v[136:139], v254, s[4:7], s30 offen offset:0 sc1
    buffer_store_dwordx4 v[140:143], v254, s[4:7], s30 offen offset:1024 sc1
L_nostore:
    s_waitcnt lgkmcnt(12)
    s_addk_i32 m0, -15360
    s_add_u32 s43, s29, 512
    buffer_load_dwordx4 v218, s[88:91], s43 offen lds
    s_addk_i32 m0, 1024
    s_addk_i32 s43, 4096
    buffer_load_dwordx4 v218, s[88:91], s43 offen lds
    s_addk_i32 m0, 1024
    s_addk_i32 s43, 12288
    buffer_load_dwordx4 v219, s[88:91], s43 offen lds
    s_addk_i32 m0, 1024
    s_addk_i32 s43, 4096
    buffer_load_dwordx4 v219, s[88:91], s43 offen lds
    s_waitcnt lgkmcnt(8)
    s_addk_i32 m0, 5120
    s_addk_i32 s43, -20352
    buffer_load_dwordx4 v218, s[88:91], s43 offen lds
    s_addk_i32 m0, 1024
    s_addk_i32 s43, 4096
    buffer_load_dwordx4 v218, s[88:91], s43 offen lds
    s_addk_i32 m0, 1024
    s_addk_i32 s43, 12288
    buffer_load_dwordx4 v219, s[88:91], s43 offen lds
    s_addk_i32 m0, 1024
    s_addk_i32 s43, 4096
    buffer_load_dwordx4 v219, s[88:91], s43 offen lds
    s_waitcnt lgkmcnt(4)
    s_add_u32 m0, s28, 65536
    s_addk_i32 s43, -20352
    buffer_load_dwordx4 v218, s[88:91], s43 offen lds
    s_addk_i32 m0, 1024
    s_addk_i32 s43, 4096
    buffer_load_dwordx4 v218, s[88:91], s43 offen lds
    s_addk_i32 m0, 1024
    s_addk_i32 s43, 12288
    buffer_load_dwordx4 v219, s[88:91], s43 offen lds
    s_addk_i32 m0, 1024
    s_addk_i32 s43, 4096
    buffer_load_dwordx4 v219, s[88:91], s43 offen lds
    s_waitcnt lgkmcnt(0)
    s_addk_i32 m0, 5120
    s_addk_i32 s43, -20352
    buffer_load_dwordx4 v218, s[88:91], s43 offen lds
    s_addk_i32 m0, 1024
    s_addk_i32 s43, 4096
    buffer_load_dwordx4 v218, s[88:91], s43 offen lds
    s_addk_i32 m0, 1024
    s_addk_i32 s43, 12288
    buffer_load_dwordx4 v219, s[88:91], s43 offen lds
    s_addk_i32 m0, 1024
    s_addk_i32 s43, 4096
    buffer_load_dwordx4 v219, s[88:91], s43 offen lds
    s_addk_i32 m0, -7168
    s_add_u32 s43, s25, 32768
    buffer_load_dwordx4 v216, s[8:11], s43 offen nt lds
    s_addk_i32 m0, 1024
    s_addk_i32 s43, 8192
    buffer_load_dwordx4 v216, s[8:11], s43 offen nt lds
    s_addk_i32 m0, 1024
    s_addk_i32 s43, 8192
    buffer_load_dwordx4 v217, s[8:11], s43 offen nt lds
    s_addk_i32 m0, 1024
    s_addk_i32 s43, 8192
    buffer_load_dwordx4 v217, s[8:11], s43 offen nt lds
    s_addk_i32 m0, 5120
    s_addk_i32 s43, -24448
    buffer_load_dwordx4 v216, s[8:11], s43 offen nt lds
    s_addk_i32 m0, 1024
    s_addk_i32 s43, 8192
    buffer_load_dwordx4 v216, s[8:11], s43 offen nt lds
    s_addk_i32 m0, 1024
    s_addk_i32 s43, 8192
    buffer_load_dwordx4 v217, s[8:11], s43 offen nt lds
    s_addk_i32 m0, 1024
    s_addk_i32 s43, 8192
    buffer_load_dwordx4 v217, s[8:11], s43 offen nt lds
    v_add_u32 v252, 131072, v254
    s_lshl_b32 s26, s24, 11
    v_add_u32 v253, s26, v252
    v_lshlrev_b32 v203, 1, v206
    s_lshl_b32 s26, s24, 8
    s_add_u32 s26, s26, 147456
    v_add_u32 v255, s26, v203
    v_mov_b32 v224, 0
    v_mov_b32 v225, 0
    v_mov_b32 v226, 0
    v_mov_b32 v227, 0
    v_mov_b32 v228, 0
    v_mov_b32 v229, 0
    v_mov_b32 v230, 0
    v_mov_b32 v231, 0
    v_mov_b32 v232, 0
    v_mov_b32 v233, 0
    v_mov_b32 v234, 0
    v_mov_b32 v235, 0
    v_cmp_gt_u32 vcc, 32, v201
    v_mov_b32 v203, 0x3f80
    s_nop 1
    v_cndmask_b32 v232, 0, v203, vcc
    s_mov_b32 s22, 0xffff0000
    s_mov_b32 s21, 0
    v_add_u32 v198, s28, v254
    v_add_u32 v199, 0x10000, v198
    s_nop 1
    v_mfma_f32_32x32x16_bf16 v[0:15], v[224:227], v[224:227], 1.0
    v_mfma_f32_32x32x16_bf16 v[16:31], v[224:227], v[224:227], 1.0
    v_mfma_f32_32x32x16_bf16 v[32:47], v[224:227], v[224:227], 1.0
    v_mfma_f32_32x32x16_bf16 v[48:63], v[224:227], v[224:227], 1.0
    v_mfma_f32_32x32x16_bf16 v[64:79], v[224:227], v[224:227], 1.0
    v_mfma_f32_32x32x16_bf16 v[80:95], v[224:227], v[224:227], 1.0
    v_mfma_f32_32x32x16_bf16 v[96:111], v[224:227], v[224:227], 1.0
    v_mfma_f32_32x32x16_bf16 v[112:127], v[224:227], v[224:227], 1.0
    s_waitcnt vmcnt(24)
    s_barrier
    s_mov_b32 s42, 0
    s_cmp_ge_u32 s3, 64
    s_cbranch_scc1 L_noflag
    s_cmp_lg_u32 s24, 0
    s_cbranch_scc1 L_noflag
    s_mov_b32 s42, 1
    v_mov_b32 v222, 1
    v_mov_b32 v223, 0
    s_mov_b64 s[36:37], exec
    s_mov_b64 exec, 1
    buffer_atomic_add v222, v223, s[92:95], 0 offen sc0
    s_mov_b64 exec, s[36:37]
L_noflag:
    s_lshl_b32 s27, s24, 11
    s_add_u32 s27, s27, 0
    s_add_u32 s26, s27, 147456
    s_mov_b32 m0, s26
    s_nop 0
    buffer_load_dwordx4 v254, s[16:19], s27 offen lds
    s_lshl_b32 s27, s24, 11
    s_add_u32 s27, s27, 1024
    s_add_u32 s26, s27, 147456
    s_mov_b32 m0, s26
    s_nop 0
    buffer_load_dwordx4 v254, s[16:19], s27 offen lds
    ds_read_b128 v[160:163], v236 offset:0
    ds_read_b128 v[164:167], v237 offset:0
    ds_read_b128 v[168:171], v238 offset:0
    ds_read_b128 v[172:175], v239 offset:0
    ds_read_b128 v[176:179], v236 offset:8192
    ds_read_b128 v[180:183], v237 offset:8192
    ds_read_b128 v[184:187], v238 offset:8192
    ds_read_b128 v[188:191], v239 offset:8192
    s_waitcnt lgkmcnt(4)
    v_mfma_f32_32x32x16_bf16 v[128:143], a[0:3], v[160:163], 0
    ds_read_b128 v[160:163], v236 offset:16384
    s_waitcnt vmcnt(22)
    ds_read_b128 a[16:19], v244 offset:0
    ds_read_b128 a[20:23], v245 offset:0
    ds_read_b128 a[48:51], v246 offset:0
    ds_read_b128 a[52:55], v247 offset:0
    v_mfma_f32_32x32x16_bf16 v[128:143], a[4:7], v[164:167], v[128:143]
    ds_read_b128 v[164:167], v237 offset:16384
    s_waitcnt vmcnt(18)
    ds_read_b128 a[80:83], v244 offset:8192
    ds_read_b128 a[84:87], v245 offset:8192
    ds_read_b128 a[112:115], v246 offset:8192
    ds_read_b128 a[116:119], v247 offset:8192
    v_mfma_f32_32x32x16_bf16 v[128:143], a[32:35], v[168:171], v[128:143]
    ds_read_b128 v[168:171], v238 offset:16384
    s_waitcnt vmcnt(14)
    ds_read_b128 a[24:27], v248 offset:0
    ds_read_b128 a[28:31], v249 offset:0
    ds_read_b128 a[56:59], v250 offset:0
    ds_read_b128 a[60:63], v251 offset:0
    v_mfma_f32_32x32x16_bf16 v[128:143], a[36:39], v[172:175], v[128:143]
    ds_read_b128 v[172:175], v239 offset:16384
    s_waitcnt vmcnt(10)
    ds_read_b128 a[88:91], v248 offset:8192
    ds_read_b128 a[92:95], v249 offset:8192
    ds_read_b128 a[120:123], v250 offset:8192
    ds_read_b128 a[124:127], v251 offset:8192
    s_waitcnt lgkmcnt(15)
    v_mfma_f32_32x32x16_bf16 v[128:143], a[64:67], v[176:179], v[128:143]
    ds_read_b128 v[176:179], v236 offset:24576
    v_mfma_f32_32x32x16_bf16 v[128:143], a[68:71], v[180:183], v[128:143]
    ds_read_b128 v[180:183], v237 offset:24576
    v_mfma_f32_32x32x16_bf16 v[128:143], a[96:99], v[184:187], v[128:143]
    ds_read_b128 v[184:187], v238 offset:24576
    s_add_u32 m0, s28, 0
    s_add_u32 s43, s29, 0
    buffer_load_dwordx4 v220, s[84:87], s43 offen lds
    v_mfma_f32_32x32x16_bf16 v[128:143], a[100:103], v[188:191], v[128:143]
    ds_read_b128 v[188:191], v239 offset:24576
    s_addk_i32 m0, 1024
    s_addk_i32 s43, 1024
    buffer_load_dwordx4 v220, s[84:87], s43 offen lds
    s_waitcnt lgkmcnt(8)
    v_mfma_f32_32x32x16_bf16 v[128:143], a[8:11], v[160:163], v[128:143]
    ds_read_b128 v[160:163], v236 offset:32768
    s_addk_i32 m0, 1024
    s_addk_i32 s43, 3072
    buffer_load_dwordx4 v221, s[84:87], s43 offen lds
    s_cmp_eq_u32 s42, 0
    s_cbranch_scc1 L_nogo
    s_waitcnt vmcnt(5)
    v_readfirstlane_b32 s42, v222
    v_mov_b32 v222, 1
    s_nop 2
    s_cmp_lg_u32 s42, 63
    s_cbranch_scc1 L_nogo
    s_mov_b64 s[36:37], exec
    s_mov_b64 exec, 1
    buffer_store_dword v222, v223, s[92:95], 0 offen offset:128 sc1
    s_mov_b64 exec, s[36:37]
L_nogo:
    v_mfma_f32_32x32x16_bf16 v[128:143], a[12:15], v[164:167], v[128:143]
    ds_read_b128 v[164:167], v237 offset:32768
    s_addk_i32 m0, 1024
    s_addk_i32 s43, 1024
    buffer_load_dwordx4 v221, s[84:87], s43 offen lds
    v_mfma_f32_32x32x16_bf16 v[128:143], a[40:43], v[168:171], v[128:143]
    ds_read_b128 v[168:171], v238 offset:32768
    s_addk_i32 m0, 5120
    s_addk_i32 s43, -4992
    buffer_load_dwordx4 v220, s[84:87], s43 offen lds
    v_mfma_f32_32x32x16_bf16 v[128:143], a[44:47], v[172:175], v[128:143]
    ds_read_b128 v[172:175], v239 offset:32768
    s_addk_i32 m0, 1024
    s_addk_i32 s43, 1024
    buffer_load_dwordx4 v220, s[84:87], s43 offen lds
    s_waitcnt lgkmcnt(4)
    v_mfma_f32_32x32x16_bf16 v[128:143], a[72:75], v[176:179], v[128:143]
    ds_read_b128 v[176:179], v236 offset:40960
    s_addk_i32 m0, 1024
    s_addk_i32 s43, 3072
    buffer_load_dwordx4 v221, s[84:87], s43 offen lds
    v_mfma_f32_32x32x16_bf16 v[128:143], a[76:79], v[180:183], v[128:143]
    ds_read_b128 v[180:183], v237 offset:40960
    s_addk_i32 m0, 1024
    s_addk_i32 s43, 1024
    buffer_load_dwordx4 v221, s[84:87], s43 offen lds
    v_mfma_f32_32x32x16_bf16 v[128:143], a[104:107], v[184:187], v[128:143]
    ds_read_b128 v[184:187], v238 offset:40960
    s_add_u32 m0, s28, 65536
    s_addk_i32 s43, 2944
    buffer_load_dwordx4 v220, s[84:87], s43 offen lds
    v_mfma_f32_32x32x16_bf16 v[128:143], a[108:111], v[188:191], v[128:143]
    ds_read_b128 v[188:191], v239 offset:40960
    s_addk_i32 m0, 1024
    s_addk_i32 s43, 1024
    buffer_load_dwordx4 v220, s[84:87], s43 offen lds
    s_waitcnt lgkmcnt(4)
    v_mfma_f32_32x32x16_bf16 v[128:143], a[16:19], v[160:163], v[128:143]
    ds_read_b128 v[160:163], v236 offset:49152
    s_addk_i32 m0, 1024
    s_addk_i32 s43, 3072
    buffer_load_dwordx4 v221, s[84:87], s43 offen lds
    v_mfma_f32_32x32x16_bf16 v[128:143], a[20:23], v[164:167], v[128:143]
    ds_read_b128 v[164:167], v237 offset:49152
    s_addk_i32 m0, 1024
    s_addk_i32 s43, 1024
    buffer_load_dwordx4 v221, s[84:87], s43 offen lds
    v_mfma_f32_32x32x16_bf16 v[128:143], a[48:51], v[168:171], v[128:143]
    ds_read_b128 v[168:171], v238 offset:49152
    s_addk_i32 m0, 5120
    s_addk_i32 s43, -4992
    buffer_load_dwordx4 v220, s[84:87], s43 offen lds
    v_mfma_f32_32x32x16_bf16 v[128:143], a[52:55], v[172:175], v[128:143]
    ds_read_b128 v[172:175], v239 offset:49152
    s_addk_i32 m0, 1024
    s_addk_i32 s43, 1024
    buffer_load_dwordx4 v220, s[84:87], s43 offen lds
    s_waitcnt lgkmcnt(4)
    v_mfma_f32_32x32x16_bf16 v[128:143], a[80:83], v[176:179], v[128:143]
    ds_read_b128 v[176:179], v236 offset:57344
    s_addk_i32 m0, 1024
    s_addk_i32 s43, 3072
    buffer_load_dwordx4 v221, s[84:87], s43 offen lds
    v_mfma_f32_32x32x16_bf16 v[128:143], a[84:87], v[180:183], v[128:143]
    ds_read_b128 v[180:183], v237 offset:57344
    s_addk_i32 m0, 1024
    s_addk_i32 s43, 1024
    buffer_load_dwordx4 v221, s[84:87], s43 offen lds
    v_mfma_f32_32x32x16_bf16 v[128:143], a[112:115], v[184:187], v[128:143]
    ds_read_b128 v[184:187], v238 offset:57344
    v_mfma_f32_32x32x16_bf16 v[128:143], a[116:119], v[188:191], v[128:143]
    ds_read_b128 v[188:191], v239 offset:57344
    s_waitcnt vmcnt(16)
    s_barrier
    v_subrev_u32 v236, 4096, v236
    v_subrev_u32 v237, 4096, v237
    v_subrev_u32 v238, 4096, v238
    v_subrev_u32 v239, 4096, v239
    s_waitcnt lgkmcnt(4)
    v_mfma_f32_32x32x16_bf16 v[128:143], a[24:27], v[160:163], v[128:143]
    ds_read_b128 v[160:163], v240 offset:0
    s_waitcnt vmcnt(12)
    ds_read_b128 a[128:131], v244 offset:0
    ds_read_b128 a[132:135], v245 offset:0
    ds_read_b128 a[136:139], v246 offset:0
    ds_read_b128 a[140:143], v247 offset:0
    v_mfma_f32_32x32x16_bf16 v[128:143], a[28:31], v[164:167], v[128:143]
    ds_read_b128 v[164:167], v241 offset:0
    s_waitcnt vmcnt(8)
    ds_read_b128 a[144:147], v244 offset:8192
    ds_read_b128 a[148:151], v245 offset:8192
    ds_read_b128 a[152:155], v246 offset:8192
    ds_read_b128 a[156:159], v247 offset:8192
    v_mfma_f32_32x32x16_bf16 v[128:143], a[56:59], v[168:171], v[128:143]
    ds_read_b128 v[168:171], v240 offset:16384
    s_waitcnt vmcnt(4)
    ds_read_b128 a[160:163], v248 offset:0
    ds_read_b128 a[164:167], v249 offset:0
    ds_read_b128 a[168:171], v250 offset:0
    ds_read_b128 a[172:175], v251 offset:0
    v_mfma_f32_32x32x16_bf16 v[128:143], a[60:63], v[172:175], v[128:143]
    ds_read_b128 v[172:175], v241 offset:16384
    s_waitcnt vmcnt(0)
    ds_read_b128 a[176:179], v248 offset:8192
    ds_read_b128 a[180:183], v249 offset:8192
    ds_read_b128 a[184:187], v250 offset:8192
    ds_read_b128 a[188:191], v251 offset:8192
    s_waitcnt lgkmcnt(15)
    v_mfma_f32_32x32x16_bf16 v[128:143], a[88:91], v[176:179], v[128:143]
    ds_read_b128 v[176:179], v240 offset:32768
    v_mfma_f32_32x32x16_bf16 v[128:143], a[92:95], v[180:183], v[128:143]
    ds_read_b128 v[180:183], v241 offset:32768
    v_mfma_f32_32x32x16_bf16 v[128:143], a[120:123], v[184:187], v[128:143]
    ds_read_b128 v[184:187], v240 offset:49152
    s_add_u32 m0, s28, 0
    s_addk_i32 s43, 2944
    buffer_load_dwordx4 v220, s[84:87], s43 offen lds
    v_mfma_f32_32x32x16_bf16 v[128:143], a[124:127], v[188:191], v[128:143]
    ds_read_b128 v[188:191], v241 offset:49152
    s_addk_i32 m0, 1024
    s_addk_i32 s43, 1024
    buffer_load_dwordx4 v220, s[84:87], s43 offen lds
    s_waitcnt lgkmcnt(8)
    v_mfma_f32_32x32x16_bf16 v[144:159], a[0:3], v[160:163], 0
    ds_read_b128 v[160:163], v242 offset:0
    s_addk_i32 m0, 1024
    s_addk_i32 s43, 3072
    buffer_load_dwordx4 v221, s[84:87], s43 offen lds
    v_mfma_f32_32x32x16_bf16 v[144:159], a[4:7], v[164:167], v[144:159]
    ds_read_b128 v[164:167], v243 offset:0
    s_addk_i32 m0, 1024
    s_addk_i32 s43, 1024
    buffer_load_dwordx4 v221, s[84:87], s43 offen lds
    v_cvt_pk_bf16_f32 v128, v128, v129
    v_mfma_f32_32x32x16_bf16 v[144:159], a[8:11], v[168:171], v[144:159]
    ds_read_b128 v[168:171], v242 offset:16384
    s_addk_i32 m0, 5120
    s_addk_i32 s43, -4992
    buffer_load_dwordx4 v220, s[84:87], s43 offen lds
    v_cvt_pk_bf16_f32 v129, v130, v131
    v_mfma_f32_32x32x16_bf16 v[144:159], a[12:15], v[172:175], v[144:159]
    ds_read_b128 v[172:175], v243 offset:16384
    s_addk_i32 m0, 1024
    s_addk_i32 s43, 1024
    buffer_load_dwordx4 v220, s[84:87], s43 offen lds
    v_cvt_pk_bf16_f32 v130, v132, v133
    s_waitcnt lgkmcnt(4)
    v_mfma_f32_32x32x16_bf16 v[144:159], a[16:19], v[176:179], v[144:159]
    ds_read_b128 v[176:179], v242 offset:32768
    s_addk_i32 m0, 1024
    s_addk_i32 s43, 3072
    buffer_load_dwordx4 v221, s[84:87], s43 offen lds
    v_mfma_f32_32x32x16_bf16 v[144:159], a[20:23], v[180:183], v[144:159]
    ds_read_b128 v[180:183], v243 offset:32768
    s_addk_i32 m0, 1024
    s_addk_i32 s43, 1024
    buffer_load_dwordx4 v221, s[84:87], s43 offen lds
    v_cvt_pk_bf16_f32 v131, v134, v135
    v_mfma_f32_32x32x16_bf16 v[144:159], a[24:27], v[184:187], v[144:159]
    ds_read_b128 v[184:187], v242 offset:49152
    s_add_u32 m0, s28, 65536
    s_addk_i32 s43, 2944
    buffer_load_dwordx4 v220, s[84:87], s43 offen lds
    v_cvt_pk_bf16_f32 v136, v136, v137
    v_mfma_f32_32x32x16_bf16 v[144:159], a[28:31], v[188:191], v[144:159]
    ds_read_b128 v[188:191], v243 offset:49152
    s_addk_i32 m0, 1024
    s_addk_i32 s43, 1024
    buffer_load_dwordx4 v220, s[84:87], s43 offen lds
    v_cvt_pk_bf16_f32 v137, v138, v139
    s_waitcnt lgkmcnt(4)
    v_mfma_f32_32x32x16_bf16 v[144:159], a[32:35], v[160:163], v[144:159]
    ds_read_b128 v[160:163], v240 offset:8192
    s_addk_i32 m0, 1024
    s_addk_i32 s43, 3072
    buffer_load_dwordx4 v221, s[84:87], s43 offen lds
    v_mfma_f32_32x32x16_bf16 v[144:159], a[36:39], v[164:167], v[144:159]
    ds_read_b128 v[164:167], v241 offset:8192
    s_addk_i32 m0, 1024
    s_addk_i32 s43, 1024
    buffer_load_dwordx4 v221, s[84:87], s43 offen lds
    v_cvt_pk_bf16_f32 v138, v140, v141
    v_mfma_f32_32x32x16_bf16 v[144:159], a[40:43], v[168:171], v[144:159]
    ds_read_b128 v[168:171], v240 offset:24576
    s_addk_i32 m0, 5120
    s_addk_i32 s43, -4992
    buffer_load_dwordx4 v220, s[84:87], s43 offen lds
    v_cvt_pk_bf16_f32 v139, v142, v143
    v_mfma_f32_32x32x16_bf16 v[144:159], a[44:47], v[172:175], v[144:159]
    ds_read_b128 v[172:175], v241 offset:24576
    s_addk_i32 m0, 1024
    s_addk_i32 s43, 1024
    buffer_load_dwordx4 v220, s[84:87], s43 offen lds
    ds_read_u16 v224, v255 offset:0
    s_waitcnt lgkmcnt(5)
    v_mfma_f32_32x32x16_bf16 v[144:159], a[48:51], v[176:179], v[144:159]
    ds_read_b128 v[176:179], v240 offset:40960
    s_addk_i32 m0, 1024
    s_addk_i32 s43, 3072
    buffer_load_dwordx4 v221, s[84:87], s43 offen lds
    v_mfma_f32_32x32x16_bf16 v[144:159], a[52:55], v[180:183], v[144:159]
    ds_read_b128 v[180:183], v241 offset:40960
    s_addk_i32 m0, 1024
    s_addk_i32 s43, 1024
    buffer_load_dwordx4 v221, s[84:87], s43 offen lds
    ds_read_u16 v226, v255 offset:64
    v_mfma_f32_32x32x16_bf16 v[144:159], a[56:59], v[184:187], v[144:159]
    ds_read_b128 v[184:187], v240 offset:57344
    ds_write_b128 v253, v[128:131] offset:0
    v_mfma_f32_32x32x16_bf16 v[144:159], a[60:63], v[188:191], v[144:159]
    ds_read_b128 v[188:191], v241 offset:57344
    ds_write_b128 v253, v[136:139] offset:1024
    s_waitcnt lgkmcnt(0)
    s_barrier
    v_mfma_f32_32x32x16_bf16 v[144:159], a[64:67], v[160:163], v[144:159]
    ds_read_b128 v[160:163], v242 offset:8192
    ds_read_u16 v228, v255 offset:128
    ds_read_u16 v230, v255 offset:192
    v_add_u32 v255, 1024, v255
    ds_read_b128 v[192:195], v244 offset:4096
    v_mfma_f32_32x32x16_bf16 v[144:159], a[68:71], v[164:167], v[144:159]
    ds_read_b128 v[164:167], v243 offset:8192
    ds_read_b128 v[196:199], v245 offset:4096
    v_mfma_f32_32x32x16_bf16 v[144:159], a[72:75], v[168:171], v[144:159]
    ds_read_b128 v[168:171], v242 offset:24576
    s_waitcnt lgkmcnt(3)
    v_lshlrev_b32 v128, 16, v192
    v_and_b32 v129, s22, v192
    v_lshlrev_b32 v130, 16, v193
    v_mfma_f32_32x32x16_bf16 v[144:159], a[76:79], v[172:175], v[144:159]
    ds_read_b128 v[172:175], v243 offset:24576
    v_and_b32 v131, s22, v193
    v_lshlrev_b32 v132, 16, v194
    v_and_b32 v133, s22, v194
    v_lshlrev_b32 v134, 16, v195
    v_mfma_f32_32x32x16_bf16 v[144:159], a[80:83], v[176:179], v[144:159]
    ds_read_b128 v[176:179], v242 offset:40960
    v_and_b32 v135, s22, v195
    ds_read_b128 v[192:195], v246 offset:4096
    s_waitcnt lgkmcnt(4)
    v_lshlrev_b32 v136, 16, v196
    v_mfma_f32_32x32x16_bf16 v[144:159], a[84:87], v[180:183], v[144:159]
    ds_read_b128 v[180:183], v243 offset:40960
    v_and_b32 v137, s22, v196
    v_lshlrev_b32 v138, 16, v197
    v_and_b32 v139, s22, v197
    v_lshlrev_b32 v140, 16, v198
    v_mfma_f32_32x32x16_bf16 v[144:159], a[88:91], v[184:187], v[144:159]
    ds_read_b128 v[184:187], v242 offset:57344
    v_and_b32 v141, s22, v198
    v_lshlrev_b32 v142, 16, v199
    v_and_b32 v143, s22, v199
    ds_read_b128 v[196:199], v247 offset:4096
    v_mfma_f32_32x32x16_bf16 v[144:159], a[92:95], v[188:191], v[144:159]
    ds_read_b128 v[188:191], v243 offset:57344
    v_mov_b32 v223, 128
    s_cmp_lg_u32 s24, 0
    s_cbranch_scc1 L_nopoll0
    buffer_load_dword v222, v223, s[92:95], 0 offen sc1
L_nopoll0:
    v_subrev_u32 v240, 4096, v240
    v_subrev_u32 v241, 4096, v241
    v_subrev_u32 v242, 4096, v242
    v_subrev_u32 v243, 4096, v243
    s_waitcnt lgkmcnt(6)
    v_mfma_f32_32x32x16_bf16 v[144:159], a[96:99], v[160:163], v[144:159]
    ds_read_b128 v[160:163], v252 offset:0
    s_waitcnt lgkmcnt(5)
    v_lshlrev_b32 v200, 16, v192
    v_and_b32 v201, s22, v192
    v_mfma_f32_32x32x16_bf16 v[144:159], a[100:103], v[164:167], v[144:159]
    ds_read_b128 v[164:167], v252 offset:1024
    v_lshlrev_b32 v202, 16, v193
    v_and_b32 v203, s22, v193
    v_lshlrev_b32 v204, 16, v194
    v_and_b32 v205, s22, v194
    v_mfma_f32_32x32x16_bf16 v[144:159], a[104:107], v[168:171], v[144:159]
    ds_read_b128 v[168:171], v252 offset:2048
    v_lshlrev_b32 v206, 16, v195
    v_and_b32 v207, s22, v195
    s_waitcnt lgkmcnt(4)
    v_lshlrev_b32 v208, 16, v196
    v_mfma_f32_32x32x16_bf16 v[144:159], a[108:111], v[172:175], v[144:159]
    ds_read_b128 v[172:175], v252 offset:3072
    v_and_b32 v209, s22, v196
    v_lshlrev_b32 v210, 16, v197
    v_and_b32 v211, s22, v197
    v_lshlrev_b32 v212, 16, v198
    s_waitcnt lgkmcnt(4)
    v_mfma_f32_32x32x16_bf16 v[144:159], a[112:115], v[176:179], v[144:159]
    ds_read_b128 v[176:179], v252 offset:4096
    s_waitcnt vmcnt(12)
    ds_read_b128 a[192:195], v244 offset:0
    ds_read_b128 a[196:199], v245 offset:0
    ds_read_b128 a[200:203], v246 offset:0
    ds_read_b128 a[204:207], v247 offset:0
    v_mfma_f32_32x32x16_bf16 v[144:159], a[116:119], v[180:183], v[144:159]
    ds_read_b128 v[180:183], v252 offset:5120
    s_waitcnt vmcnt(8)
    ds_read_b128 a[208:211], v244 offset:8192
    ds_read_b128 a[212:215], v245 offset:8192
    ds_read_b128 a[216:219], v246 offset:8192
    ds_read_b128 a[220:223], v247 offset:8192
    v_mfma_f32_32x32x16_bf16 v[144:159], a[120:123], v[184:187], v[144:159]
    ds_read_b128 v[184:187], v252 offset:6144
    s_waitcnt vmcnt(4)
    ds_read_b128 a[224:227], v248 offset:0
    ds_read_b128 a[228:231], v249 offset:0
    ds_read_b128 a[232:235], v250 offset:0
    ds_read_b128 a[236:239], v251 offset:0
    v_mfma_f32_32x32x16_bf16 v[144:159], a[124:127], v[188:191], v[144:159]
    ds_read_b128 v[188:191], v252 offset:7168
    s_waitcnt vmcnt(0)
    ds_read_b128 a[240:243], v248 offset:8192
    ds_read_b128 a[244:247], v249 offset:8192
    ds_read_b128 a[248:251], v250 offset:8192
    ds_read_b128 a[252:255], v251 offset:8192
    s_cmp_lg_u32 s24, 0
    s_cbranch_scc1 L_polldone
    s_waitcnt vmcnt(0)
    s_mov_b32 s26, 0
L_poll:
    v_cmp_ne_u32 vcc, 0, v222
    s_nop 3
    s_cmp_eq_u64 vcc, -1
    s_cbranch_scc1 L_polldone
    s_add_u32 s26, s26, 1
    s_cmp_ge_u32 s26, 2000
    s_cbranch_scc1 L_polldone
    s_sleep 4
    buffer_load_dword v222, v223, s[92:95], 0 offen sc1
    s_waitcnt vmcnt(0)
    s_branch L_poll
L_polldone:
    s_barrier
    v_and_b32 v213, s22, v198
    v_lshlrev_b32 v214, 16, v199
    v_and_b32 v215, s22, v199
.p2align 3
L_loop:
    s_waitcnt vmcnt(28) lgkmcnt(4)
    v_mfma_f32_32x32x16_bf16 v[0:15], v[224:227], v[232:235], v[0:15]
    ds_read_b128 v[192:195], v244 offset:12288
    ds_read_b128 v[196:199], v245 offset:12288
    v_mfma_f32_32x32x16_bf16 v[0:15], a[128:131], v[160:163], v[0:15]
    buffer_load_dwordx4 a[0:3], v254, s[4:7], s20 offen offset:0 sc1
    v_mfma_f32_32x32x16_bf16 v[0:15], a[132:135], v[164:167], v[0:15]
    v_mfma_f32_32x32x16_bf16 v[0:15], a[136:139], v[168:171], v[0:15]
    buffer_load_dwordx4 a[4:7], v254, s[4:7], s20 offen offset:1024 sc1
    v_mfma_f32_32x32x16_bf16 v[0:15], a[140:143], v[172:175], v[0:15]
    s_waitcnt vmcnt(26) lgkmcnt(2)
    v_mfma_f32_32x32x16_bf16 v[0:15], a[144:147], v[176:179], v[0:15]
    buffer_load_dwordx4 a[8:11], v254, s[4:7], s20 offen offset:2048 sc1
    v_cvt_pk_bf16_f32 v144, v144, v145
    v_cvt_pk_bf16_f32 v145, v146, v147
    v_cvt_pk_bf16_f32 v146, v148, v149
    v_mfma_f32_32x32x16_bf16 v[0:15], a[148:151], v[180:183], v[0:15]
    v_cvt_pk_bf16_f32 v147, v150, v151
    ds_write_b128 v253, v[144:147] offset:8192
    v_mfma_f32_32x32x16_bf16 v[0:15], a[152:155], v[184:187], v[0:15]
    buffer_load_dwordx4 a[12:15], v254, s[4:7], s20 offen offset:3072 sc1
    s_add_u32 s20, s20, 4096
    v_cvt_pk_bf16_f32 v152, v152, v153
    v_cvt_pk_bf16_f32 v153, v154, v155
    v_cvt_pk_bf16_f32 v154, v156, v157
    v_mfma_f32_32x32x16_bf16 v[0:15], a[156:159], v[188:191], v[0:15]
    v_cvt_pk_bf16_f32 v155, v158, v159
    ds_write_b128 v253, v[152:155] offset:9216
    s_waitcnt vmcnt(24)
    v_mfma_f32_32x32x16_bf16 v[16:31], v[226:229], v[232:235], v[16:31]
    buffer_load_dwordx4 a[16:19], v254, s[4:7], s20 offen offset:0 sc1
    s_waitcnt lgkmcnt(3)
    v_lshlrev_b32 v144, 16, v192
    v_and_b32 v145, s22, v192
    v_mfma_f32_32x32x16_bf16 v[16:31], a[160:163], v[160:163], v[16:31]
    v_lshlrev_b32 v146, 16, v193
    v_and_b32 v147, s22, v193
    v_lshlrev_b32 v148, 16, v194
    v_mul_f32 v128, v128, v0
    v_mul_f32 v129, v129, v1
    v_mfma_f32_32x32x16_bf16 v[16:31], a[164:167], v[164:167], v[16:31]
    buffer_load_dwordx4 a[20:23], v254, s[4:7], s20 offen offset:1024 sc1
    v_mul_f32 v130, v130, v2
    v_mul_f32 v131, v131, v3
    v_mul_f32 v132, v132, v4
    v_mul_f32 v133, v133, v5
    v_mfma_f32_32x32x16_bf16 v[16:31], a[168:171], v[168:171], v[16:31]
    v_mul_f32 v134, v134, v6
    v_mul_f32 v135, v135, v7
    v_cvt_pk_bf16_f32 v216, v128, v129
    v_cvt_pk_bf16_f32 v217, v130, v131
    v_cvt_pk_bf16_f32 v218, v132, v133
    v_mfma_f32_32x32x16_bf16 v[16:31], a[172:175], v[172:175], v[16:31]
    buffer_load_dwordx4 a[24:27], v254, s[4:7], s20 offen offset:2048 sc1
    v_cvt_pk_bf16_f32 v219, v134, v135
    ds_write_b128 v244, v[216:219] offset:0
    s_waitcnt vmcnt(23)
    v_mfma_f32_32x32x16_bf16 v[16:31], a[176:179], v[176:179], v[16:31]
    v_mul_f32 v136, v136, v8
    v_mul_f32 v137, v137, v9
    v_mul_f32 v138, v138, v10
    v_mul_f32 v139, v139, v11
    v_mfma_f32_32x32x16_bf16 v[16:31], a[180:183], v[180:183], v[16:31]
    buffer_load_dwordx4 a[28:31], v254, s[4:7], s20 offen offset:3072 sc1
    s_add_u32 s20, s20, 4096
    v_mul_f32 v140, v140, v12
    v_mul_f32 v141, v141, v13
    v_mul_f32 v142, v142, v14
    v_mfma_f32_32x32x16_bf16 v[16:31], a[184:187], v[184:187], v[16:31]
    v_mul_f32 v143, v143, v15
    v_cvt_pk_bf16_f32 v220, v136, v137
    v_cvt_pk_bf16_f32 v221, v138, v139
    v_cvt_pk_bf16_f32 v222, v140, v141
    v_cvt_pk_bf16_f32 v223, v142, v143
    v_mfma_f32_32x32x16_bf16 v[16:31], a[188:191], v[188:191], v[16:31]
    buffer_load_dwordx4 a[32:35], v254, s[4:7], s20 offen offset:0 sc1
    ds_write_b128 v245, v[220:223] offset:0
    s_waitcnt vmcnt(21)
    v_mfma_f32_32x32x16_bf16 v[32:47], v[228:231], v[232:235], v[32:47]
    v_and_b32 v149, s22, v194
    v_lshlrev_b32 v150, 16, v195
    v_and_b32 v151, s22, v195
    ds_read_b128 v[192:195], v246 offset:12288
    v_mfma_f32_32x32x16_bf16 v[32:47], a[192:195], v[160:163], v[32:47]
    buffer_load_dwordx4 a[36:39], v254, s[4:7], s20 offen offset:1024 sc1
    s_waitcnt lgkmcnt(5)
    v_lshlrev_b32 v152, 16, v196
    v_mul_f32 v200, v200, v16
    v_mul_f32 v201, v201, v17
    v_mfma_f32_32x32x16_bf16 v[32:47], a[196:199], v[164:167], v[32:47]
    v_mul_f32 v202, v202, v18
    v_mul_f32 v203, v203, v19
    v_mul_f32 v204, v204, v20
    s_waitcnt lgkmcnt(3)
    s_barrier
    v_mfma_f32_32x32x16_bf16 v[32:47], a[200:203], v[168:171], v[32:47]
    buffer_load_dwordx4 a[40:43], v254, s[4:7], s20 offen offset:2048 sc1
    v_mul_f32 v205, v205, v21
    v_mul_f32 v206, v206, v22
    v_mul_f32 v207, v207, v23
    v_cvt_pk_bf16_f32 v216, v200, v201
    v_mfma_f32_32x32x16_bf16 v[32:47], a[204:207], v[172:175], v[32:47]
    v_cvt_pk_bf16_f32 v217, v202, v203
    v_cvt_pk_bf16_f32 v218, v204, v205
    v_cvt_pk_bf16_f32 v219, v206, v207
    v_mul_f32 v208, v208, v24
    v_mul_f32 v209, v209, v25
    s_waitcnt vmcnt(19)
    v_mfma_f32_32x32x16_bf16 v[32:47], a[208:211], v[176:179], v[32:47]
    buffer_load_dwordx4 a[44:47], v254, s[4:7], s20 offen offset:3072 sc1
    s_add_u32 s20, s20, 4096
    v_mul_f32 v210, v210, v26
    v_mul_f32 v211, v211, v27
    v_mfma_f32_32x32x16_bf16 v[32:47], a[212:215], v[180:183], v[32:47]
    ds_write_b128 v246, v[216:219] offset:0
    v_mfma_f32_32x32x16_bf16 v[32:47], a[216:219], v[184:187], v[32:47]
    buffer_load_dwordx4 a[48:51], v254, s[4:7], s20 offen offset:0 sc1
    v_mul_f32 v212, v212, v28
    v_mul_f32 v213, v213, v29
    v_mul_f32 v214, v214, v30
    v_mul_f32 v215, v215, v31
    v_mfma_f32_32x32x16_bf16 v[32:47], a[220:223], v[188:191], v[32:47]
    v_cvt_pk_bf16_f32 v220, v208, v209
    v_cvt_pk_bf16_f32 v221, v210, v211
    v_cvt_pk_bf16_f32 v222, v212, v213
    v_cvt_pk_bf16_f32 v223, v214, v215
    v_and_b32 v153, s22, v196
    s_waitcnt vmcnt(17)
    v_mfma_f32_32x32x16_bf16 v[48:63], v[230:233], v[232:235], v[48:63]
    buffer_load_dwordx4 a[52:55], v254, s[4:7], s20 offen offset:1024 sc1
    ds_write_b128 v247, v[220:223] offset:0
    v_mfma_f32_32x32x16_bf16 v[48:63], a[224:227], v[160:163], v[48:63]
    ds_read_b128 v[160:163], v252 offset:8192
    v_lshlrev_b32 v154, 16, v197
    v_mul_f32 v144, v144, v32
    v_mul_f32 v145, v145, v33
    v_mul_f32 v146, v146, v34
    v_mfma_f32_32x32x16_bf16 v[48:63], a[228:231], v[164:167], v[48:63]
    ds_read_b128 v[164:167], v252 offset:9216
    buffer_load_dwordx4 a[56:59], v254, s[4:7], s20 offen offset:2048 sc1
    v_mul_f32 v147, v147, v35
    v_mul_f32 v148, v148, v36
    v_mul_f32 v149, v149, v37
    v_mfma_f32_32x32x16_bf16 v[48:63], a[232:235], v[168:171], v[48:63]
    ds_read_b128 v[168:171], v252 offset:10240
    v_mul_f32 v150, v150, v38
    v_mul_f32 v151, v151, v39
    v_cvt_pk_bf16_f32 v216, v144, v145
    v_cvt_pk_bf16_f32 v217, v146, v147
    v_mfma_f32_32x32x16_bf16 v[48:63], a[236:239], v[172:175], v[48:63]
    ds_read_b128 v[172:175], v252 offset:11264
    buffer_load_dwordx4 a[60:63], v254, s[4:7], s20 offen offset:3072 sc1
    s_add_u32 s20, s20, 4096
    v_cvt_pk_bf16_f32 v218, v148, v149
    v_cvt_pk_bf16_f32 v219, v150, v151
    s_waitcnt vmcnt(16)
    v_mfma_f32_32x32x16_bf16 v[48:63], a[240:243], v[176:179], v[48:63]
    ds_read_b128 v[176:179], v252 offset:12288
    ds_write_b128 v244, v[216:219] offset:8192
    v_mfma_f32_32x32x16_bf16 v[48:63], a[244:247], v[180:183], v[48:63]
    ds_read_b128 v[180:183], v252 offset:13312
    buffer_load_dwordx4 a[64:67], v254, s[4:7], s20 offen offset:0 sc1
    v_and_b32 v155, s22, v197
    v_lshlrev_b32 v156, 16, v198
    v_and_b32 v157, s22, v198
    v_mfma_f32_32x32x16_bf16 v[48:63], a[248:251], v[184:187], v[48:63]
    ds_read_b128 v[184:187], v252 offset:14336
    v_lshlrev_b32 v158, 16, v199
    v_and_b32 v159, s22, v199
    ds_read_b128 v[196:199], v247 offset:12288
    v_mul_f32 v152, v152, v40
    v_mfma_f32_32x32x16_bf16 v[48:63], a[252:255], v[188:191], v[48:63]
    ds_read_b128 v[188:191], v252 offset:15360
    buffer_load_dwordx4 a[68:71], v254, s[4:7], s20 offen offset:1024 sc1
    v_mul_f32 v153, v153, v41
    v_mul_f32 v154, v154, v42
    v_mul_f32 v155, v155, v43
    s_waitcnt lgkmcnt(6)
    v_mfma_f32_32x32x16_bf16 v[64:79], v[224:227], v[232:235], v[64:79]
    v_mul_f32 v156, v156, v44
    v_mul_f32 v157, v157, v45
    v_mul_f32 v158, v158, v46
    v_mul_f32 v159, v159, v47
    v_mfma_f32_32x32x16_bf16 v[64:79], a[128:131], v[160:163], v[64:79]
    buffer_load_dwordx4 a[72:75], v254, s[4:7], s20 offen offset:2048 sc1
    v_cvt_pk_bf16_f32 v220, v152, v153
    v_cvt_pk_bf16_f32 v221, v154, v155
    v_cvt_pk_bf16_f32 v222, v156, v157
    v_cvt_pk_bf16_f32 v223, v158, v159
    v_mfma_f32_32x32x16_bf16 v[64:79], a[132:135], v[164:167], v[64:79]
    ds_write_b128 v245, v[220:223] offset:8192
    v_mfma_f32_32x32x16_bf16 v[64:79], a[136:139], v[168:171], v[64:79]
    buffer_load_dwordx4 a[76:79], v254, s[4:7], s20 offen offset:3072 sc1
    s_add_u32 s20, s20, 4096
    v_lshlrev_b32 v128, 16, v192
    v_and_b32 v129, s22, v192
    v_lshlrev_b32 v130, 16, v193
    v_mfma_f32_32x32x16_bf16 v[64:79], a[140:143], v[172:175], v[64:79]
    v_and_b32 v131, s22, v193
    v_lshlrev_b32 v132, 16, v194
    v_and_b32 v133, s22, v194
    v_lshlrev_b32 v134, 16, v195
    v_and_b32 v135, s22, v195
    s_waitcnt lgkmcnt(1)
    v_mfma_f32_32x32x16_bf16 v[64:79], a[144:147], v[176:179], v[64:79]
    buffer_load_dwordx4 a[80:83], v254, s[4:7], s20 offen offset:0 sc1
    ds_read_b128 v[192:195], v248 offset:4096
    v_mul_f32 v128, v128, v48
    v_mul_f32 v129, v129, v49
    v_mfma_f32_32x32x16_bf16 v[64:79], a[148:151], v[180:183], v[64:79]
    v_mul_f32 v130, v130, v50
    v_mul_f32 v131, v131, v51
    v_mul_f32 v132, v132, v52
    v_mul_f32 v133, v133, v53
    v_mul_f32 v134, v134, v54
    v_mfma_f32_32x32x16_bf16 v[64:79], a[152:155], v[184:187], v[64:79]
    buffer_load_dwordx4 a[84:87], v254, s[4:7], s20 offen offset:1024 sc1
    v_mul_f32 v135, v135, v55
    v_cvt_pk_bf16_f32 v216, v128, v129
    v_cvt_pk_bf16_f32 v217, v130, v131
    v_cvt_pk_bf16_f32 v218, v132, v133
    v_mfma_f32_32x32x16_bf16 v[64:79], a[156:159], v[188:191], v[64:79]
    v_cvt_pk_bf16_f32 v219, v134, v135
    ds_write_b128 v246, v[216:219] offset:8192
    v_mfma_f32_32x32x16_bf16 v[80:95], v[226:229], v[232:235], v[80:95]
    buffer_load_dwordx4 a[88:91], v254, s[4:7], s20 offen offset:2048 sc1
    v_lshlrev_b32 v136, 16, v196
    v_and_b32 v137, s22, v196
    v_lshlrev_b32 v138, 16, v197
    v_and_b32 v139, s22, v197
    v_mfma_f32_32x32x16_bf16 v[80:95], a[160:163], v[160:163], v[80:95]
    v_lshlrev_b32 v140, 16, v198
    v_and_b32 v141, s22, v198
    v_lshlrev_b32 v142, 16, v199
    v_and_b32 v143, s22, v199
    ds_read_b128 v[196:199], v249 offset:4096
    v_mfma_f32_32x32x16_bf16 v[80:95], a[164:167], v[164:167], v[80:95]
    buffer_load_dwordx4 a[92:95], v254, s[4:7], s20 offen offset:3072 sc1
    s_add_u32 s20, s20, 4096
    v_mul_f32 v136, v136, v56
    v_mul_f32 v137, v137, v57
    v_mul_f32 v138, v138, v58
    v_mfma_f32_32x32x16_bf16 v[80:95], a[168:171], v[168:171], v[80:95]
    v_mul_f32 v139, v139, v59
    v_mul_f32 v140, v140, v60
    v_mul_f32 v141, v141, v61
    v_mul_f32 v142, v142, v62
    v_mul_f32 v143, v143, v63
    v_mfma_f32_32x32x16_bf16 v[80:95], a[172:175], v[172:175], v[80:95]
    buffer_load_dwordx4 a[96:99], v254, s[4:7], s20 offen offset:0 sc1
    v_cvt_pk_bf16_f32 v220, v136, v137
    v_cvt_pk_bf16_f32 v221, v138, v139
    v_cvt_pk_bf16_f32 v222, v140, v141
    v_cvt_pk_bf16_f32 v223, v142, v143
    v_mfma_f32_32x32x16_bf16 v[80:95], a[176:179], v[176:179], v[80:95]
    ds_write_b128 v247, v[220:223] offset:8192
    v_mfma_f32_32x32x16_bf16 v[80:95], a[180:183], v[180:183], v[80:95]
    buffer_load_dwordx4 a[100:103], v254, s[4:7], s20 offen offset:1024 sc1
    s_waitcnt lgkmcnt(3)
    v_lshlrev_b32 v200, 16, v192
    v_and_b32 v201, s22, v192
    v_lshlrev_b32 v202, 16, v193
    v_mfma_f32_32x32x16_bf16 v[80:95], a[184:187], v[184:187], v[80:95]
    v_and_b32 v203, s22, v193
    v_lshlrev_b32 v204, 16, v194
    v_and_b32 v205, s22, v194
    v_lshlrev_b32 v206, 16, v195
    v_and_b32 v207, s22, v195
    v_mfma_f32_32x32x16_bf16 v[80:95], a[188:191], v[188:191], v[80:95]
    buffer_load_dwordx4 a[104:107], v254, s[4:7], s20 offen offset:2048 sc1
    ds_read_b128 v[192:195], v250 offset:4096
    v_mul_f32 v200, v200, v64
    v_mul_f32 v201, v201, v65
    v_mul_f32 v202, v202, v66
    v_mfma_f32_32x32x16_bf16 v[96:111], v[228:231], v[232:235], v[96:111]
    v_mul_f32 v203, v203, v67
    v_mul_f32 v204, v204, v68
    v_mul_f32 v205, v205, v69
    v_mul_f32 v206, v206, v70
    v_mul_f32 v207, v207, v71
    v_mfma_f32_32x32x16_bf16 v[96:111], a[192:195], v[160:163], v[96:111]
    buffer_load_dwordx4 a[108:111], v254, s[4:7], s20 offen offset:3072 sc1
    s_add_u32 s20, s20, 4096
    v_cvt_pk_bf16_f32 v216, v200, v201
    v_cvt_pk_bf16_f32 v217, v202, v203
    v_cvt_pk_bf16_f32 v218, v204, v205
    v_mfma_f32_32x32x16_bf16 v[96:111], a[196:199], v[164:167], v[96:111]
    v_cvt_pk_bf16_f32 v219, v206, v207
    ds_write_b128 v248, v[216:219] offset:0
    v_mfma_f32_32x32x16_bf16 v[96:111], a[200:203], v[168:171], v[96:111]
    buffer_load_dwordx4 a[112:115], v254, s[4:7], s20 offen offset:0 sc1
    s_waitcnt lgkmcnt(3)
    v_lshlrev_b32 v208, 16, v196
    v_and_b32 v209, s22, v196
    v_lshlrev_b32 v210, 16, v197
    v_mfma_f32_32x32x16_bf16 v[96:111], a[204:207], v[172:175], v[96:111]
    v_and_b32 v211, s22, v197
    v_lshlrev_b32 v212, 16, v198
    v_and_b32 v213, s22, v198
    v_lshlrev_b32 v214, 16, v199
    v_and_b32 v215, s22, v199
    v_mfma_f32_32x32x16_bf16 v[96:111], a[208:211], v[176:179], v[96:111]
    buffer_load_dwordx4 a[116:119], v254, s[4:7], s20 offen offset:1024 sc1
    ds_read_b128 v[196:199], v251 offset:4096
    v_mul_f32 v208, v208, v72
    v_mul_f32 v209, v209, v73
    v_mul_f32 v210, v210, v74
    v_mfma_f32_32x32x16_bf16 v[96:111], a[212:215], v[180:183], v[96:111]
    v_mul_f32 v211, v211, v75
    v_mul_f32 v212, v212, v76
    v_mul_f32 v213, v213, v77
    v_mul_f32 v214, v214, v78
    v_mul_f32 v215, v215, v79
    v_mfma_f32_32x32x16_bf16 v[96:111], a[216:219], v[184:187], v[96:111]
    buffer_load_dwordx4 a[120:123], v254, s[4:7], s20 offen offset:2048 sc1
    v_cvt_pk_bf16_f32 v220, v208, v209
    v_cvt_pk_bf16_f32 v221, v210, v211
    v_cvt_pk_bf16_f32 v222, v212, v213
    v_cvt_pk_bf16_f32 v223, v214, v215
    v_mfma_f32_32x32x16_bf16 v[96:111], a[220:223], v[188:191], v[96:111]
    ds_write_b128 v249, v[220:223] offset:0
    v_mfma_f32_32x32x16_bf16 v[112:127], v[230:233], v[232:235], v[112:127]
    buffer_load_dwordx4 a[124:127], v254, s[4:7], s20 offen offset:3072 sc1
    s_add_u32 s20, s20, 4096
    s_waitcnt lgkmcnt(3)
    v_lshlrev_b32 v144, 16, v192
    s_barrier
    v_mfma_f32_32x32x16_bf16 v[112:127], a[224:227], v[160:163], v[112:127]
    ds_read_b128 v[160:163], v236 offset:0
    v_and_b32 v145, s22, v192
    v_lshlrev_b32 v146, 16, v193
    v_and_b32 v147, s22, v193
    v_lshlrev_b32 v148, 16, v194
    v_mfma_f32_32x32x16_bf16 v[112:127], a[228:231], v[164:167], v[112:127]
    ds_read_b128 v[164:167], v237 offset:0
    v_and_b32 v149, s22, v194
    v_lshlrev_b32 v150, 16, v195
    v_and_b32 v151, s22, v195
    ds_read_b128 v[192:195], v248 offset:12288
    v_mfma_f32_32x32x16_bf16 v[112:127], a[232:235], v[168:171], v[112:127]
    ds_read_b128 v[168:171], v236 offset:16384
    v_mul_f32 v144, v144, v80
    v_mul_f32 v145, v145, v81
    v_mul_f32 v146, v146, v82
    v_mul_f32 v147, v147, v83
    v_mfma_f32_32x32x16_bf16 v[112:127], a[236:239], v[172:175], v[112:127]
    ds_read_b128 v[172:175], v237 offset:16384
    v_mul_f32 v148, v148, v84
    v_mul_f32 v149, v149, v85
    v_mul_f32 v150, v150, v86
    v_mul_f32 v151, v151, v87
    v_mfma_f32_32x32x16_bf16 v[112:127], a[240:243], v[176:179], v[112:127]
    ds_read_b128 v[176:179], v236 offset:32768
    v_cvt_pk_bf16_f32 v216, v144, v145
    v_cvt_pk_bf16_f32 v217, v146, v147
    v_cvt_pk_bf16_f32 v218, v148, v149
    v_cvt_pk_bf16_f32 v219, v150, v151
    v_mfma_f32_32x32x16_bf16 v[112:127], a[244:247], v[180:183], v[112:127]
    ds_read_b128 v[180:183], v237 offset:32768
    buffer_load_dwordx4 a[128:131], v254, s[4:7], s20 offen offset:0 sc1
    ds_write_b128 v250, v[216:219] offset:0
    v_mfma_f32_32x32x16_bf16 v[112:127], a[248:251], v[184:187], v[112:127]
    ds_read_b128 v[184:187], v236 offset:49152
    s_add_u32 s21, s21, 1
    s_waitcnt lgkmcnt(10)
    v_lshlrev_b32 v152, 16, v196
    v_and_b32 v153, s22, v196
    v_mfma_f32_32x32x16_bf16 v[112:127], a[252:255], v[188:191], v[112:127]
    ds_read_b128 v[188:191], v237 offset:49152
    buffer_load_dwordx4 a[132:135], v254, s[4:7], s20 offen offset:1024 sc1
    v_lshlrev_b32 v154, 16, v197
    v_and_b32 v155, s22, v197
    v_lshlrev_b32 v156, 16, v198
    s_cmp_eq_u32 s21, 6
    s_cbranch_scc1 L_epi
    s_waitcnt vmcnt(30) lgkmcnt(5)
    v_mfma_f32_32x32x16_bf16 v[128:143], a[0:3], v[160:163], 0
    ds_read_b128 v[160:163], v238 offset:0
    v_and_b32 v157, s22, v198
    v_lshlrev_b32 v158, 16, v199
    v_and_b32 v159, s22, v199
    v_mfma_f32_32x32x16_bf16 v[128:143], a[4:7], v[164:167], v[128:143]
    ds_read_b128 v[164:167], v239 offset:0
    buffer_load_dwordx4 a[136:139], v254, s[4:7], s20 offen offset:2048 sc1
    ds_read_b128 v[196:199], v249 offset:12288
    v_mul_f32 v152, v152, v88
    v_mul_f32 v153, v153, v89
    v_mfma_f32_32x32x16_bf16 v[128:143], a[8:11], v[168:171], v[128:143]
    ds_read_b128 v[168:171], v238 offset:16384
    v_mul_f32 v154, v154, v90
    v_mul_f32 v155, v155, v91
    v_mul_f32 v156, v156, v92
    v_mul_f32 v157, v157, v93
    v_mfma_f32_32x32x16_bf16 v[128:143], a[12:15], v[172:175], v[128:143]
    ds_read_b128 v[172:175], v239 offset:16384
    buffer_load_dwordx4 a[140:143], v254, s[4:7], s20 offen offset:3072 sc1
    s_add_u32 s20, s20, 4096
    v_mul_f32 v158, v158, v94
    v_mul_f32 v159, v159, v95
    s_waitcnt vmcnt(28) lgkmcnt(5)
    v_mfma_f32_32x32x16_bf16 v[128:143], a[16:19], v[176:179], v[128:143]
    ds_read_b128 v[176:179], v238 offset:32768
    v_cvt_pk_bf16_f32 v220, v152, v153
    v_cvt_pk_bf16_f32 v221, v154, v155
    v_cvt_pk_bf16_f32 v222, v156, v157
    v_mfma_f32_32x32x16_bf16 v[128:143], a[20:23], v[180:183], v[128:143]
    ds_read_b128 v[180:183], v239 offset:32768
    buffer_load_dwordx4 a[144:147], v254, s[4:7], s20 offen offset:0 sc1
    v_cvt_pk_bf16_f32 v223, v158, v159
    v_lshlrev_b32 v200, 16, v192
    v_and_b32 v201, s22, v192
    v_mfma_f32_32x32x16_bf16 v[128:143], a[24:27], v[184:187], v[128:143]
    ds_read_b128 v[184:187], v238 offset:49152
    ds_write_b128 v251, v[220:223] offset:0
    v_mfma_f32_32x32x16_bf16 v[128:143], a[28:31], v[188:191], v[128:143]
    ds_read_b128 v[188:191], v239 offset:49152
    buffer_load_dwordx4 a[148:151], v254, s[4:7], s20 offen offset:1024 sc1
    v_lshlrev_b32 v202, 16, v193
    v_and_b32 v203, s22, v193
    v_lshlrev_b32 v204, 16, v194
    s_waitcnt vmcnt(26) lgkmcnt(5)
    v_mfma_f32_32x32x16_bf16 v[128:143], a[32:35], v[160:163], v[128:143]
    ds_read_b128 v[160:163], v236 offset:8192
    v_and_b32 v205, s22, v194
    v_lshlrev_b32 v206, 16, v195
    v_and_b32 v207, s22, v195
    v_mfma_f32_32x32x16_bf16 v[128:143], a[36:39], v[164:167], v[128:143]
    ds_read_b128 v[164:167], v237 offset:8192
    buffer_load_dwordx4 a[152:155], v254, s[4:7], s20 offen offset:2048 sc1
    ds_read_b128 v[192:195], v250 offset:12288
    v_mul_f32 v200, v200, v96
    v_mul_f32 v201, v201, v97
    v_mfma_f32_32x32x16_bf16 v[128:143], a[40:43], v[168:171], v[128:143]
    ds_read_b128 v[168:171], v236 offset:24576
    v_mul_f32 v202, v202, v98
    v_mul_f32 v203, v203, v99
    v_mul_f32 v204, v204, v100
    v_mul_f32 v205, v205, v101
    v_mfma_f32_32x32x16_bf16 v[128:143], a[44:47], v[172:175], v[128:143]
    ds_read_b128 v[172:175], v237 offset:24576
    buffer_load_dwordx4 a[156:159], v254, s[4:7], s20 offen offset:3072 sc1
    s_add_u32 s20, s20, 4096
    v_mul_f32 v206, v206, v102
    v_mul_f32 v207, v207, v103
    s_waitcnt vmcnt(24) lgkmcnt(5)
    v_mfma_f32_32x32x16_bf16 v[128:143], a[48:51], v[176:179], v[128:143]
    ds_read_b128 v[176:179], v236 offset:40960
    v_cvt_pk_bf16_f32 v216, v200, v201
    v_cvt_pk_bf16_f32 v217, v202, v203
    v_cvt_pk_bf16_f32 v218, v204, v205
    v_mfma_f32_32x32x16_bf16 v[128:143], a[52:55], v[180:183], v[128:143]
    ds_read_b128 v[180:183], v237 offset:40960
    buffer_load_dwordx4 a[160:163], v254, s[4:7], s20 offen offset:0 sc1
    v_cvt_pk_bf16_f32 v219, v206, v207
    v_lshlrev_b32 v208, 16, v196
    v_and_b32 v209, s22, v196
    v_mfma_f32_32x32x16_bf16 v[128:143], a[56:59], v[184:187], v[128:143]
    ds_read_b128 v[184:187], v236 offset:57344
    ds_write_b128 v248, v[216:219] offset:8192
    v_mfma_f32_32x32x16_bf16 v[128:143], a[60:63], v[188:191], v[128:143]
    ds_read_b128 v[188:191], v237 offset:57344
    buffer_load_dwordx4 a[164:167], v254, s[4:7], s20 offen offset:1024 sc1
    v_lshlrev_b32 v210, 16, v197
    v_and_b32 v211, s22, v197
    v_lshlrev_b32 v212, 16, v198
    s_waitcnt vmcnt(22) lgkmcnt(5)
    v_mfma_f32_32x32x16_bf16 v[128:143], a[64:67], v[160:163], v[128:143]
    ds_read_b128 v[160:163], v238 offset:8192
    v_and_b32 v213, s22, v198
    v_lshlrev_b32 v214, 16, v199
    v_and_b32 v215, s22, v199
    v_mfma_f32_32x32x16_bf16 v[128:143], a[68:71], v[164:167], v[128:143]
    ds_read_b128 v[164:167], v239 offset:8192
    buffer_load_dwordx4 a[168:171], v254, s[4:7], s20 offen offset:2048 sc1
    ds_read_b128 v[196:199], v251 offset:12288
    v_mul_f32 v208, v208, v104
    v_mul_f32 v209, v209, v105
    v_mfma_f32_32x32x16_bf16 v[128:143], a[72:75], v[168:171], v[128:143]
    ds_read_b128 v[168:171], v238 offset:24576
    v_mul_f32 v210, v210, v106
    v_mul_f32 v211, v211, v107
    v_mul_f32 v212, v212, v108
    v_mul_f32 v213, v213, v109
    v_mfma_f32_32x32x16_bf16 v[128:143], a[76:79], v[172:175], v[128:143]
    ds_read_b128 v[172:175], v239 offset:24576
    buffer_load_dwordx4 a[172:175], v254, s[4:7], s20 offen offset:3072 sc1
    s_add_u32 s20, s20, 4096
    v_mul_f32 v214, v214, v110
    v_mul_f32 v215, v215, v111
    s_waitcnt vmcnt(20) lgkmcnt(5)
    v_mfma_f32_32x32x16_bf16 v[128:143], a[80:83], v[176:179], v[128:143]
    ds_read_b128 v[176:179], v238 offset:40960
    v_cvt_pk_bf16_f32 v220, v208, v209
    v_cvt_pk_bf16_f32 v221, v210, v211
    v_cvt_pk_bf16_f32 v222, v212, v213
    v_mfma_f32_32x32x16_bf16 v[128:143], a[84:87], v[180:183], v[128:143]
    ds_read_b128 v[180:183], v239 offset:40960
    buffer_load_dwordx4 a[176:179], v254, s[4:7], s20 offen offset:0 sc1
    v_cvt_pk_bf16_f32 v223, v214, v215
    v_lshlrev_b32 v200, 16, v192
    v_and_b32 v201, s22, v192
    v_mfma_f32_32x32x16_bf16 v[128:143], a[88:91], v[184:187], v[128:143]
    ds_read_b128 v[184:187], v238 offset:57344
    ds_write_b128 v249, v[220:223] offset:8192
    v_mfma_f32_32x32x16_bf16 v[128:143], a[92:95], v[188:191], v[128:143]
    ds_read_b128 v[188:191], v239 offset:57344
    buffer_load_dwordx4 a[180:183], v254, s[4:7], s20 offen offset:1024 sc1
    v_lshlrev_b32 v202, 16, v193
    s_barrier
    s_waitcnt vmcnt(18) lgkmcnt(5)
    v_mfma_f32_32x32x16_bf16 v[128:143], a[96:99], v[160:163], v[128:143]
    ds_read_b128 v[160:163], v240 offset:0
    v_and_b32 v203, s22, v193
    v_lshlrev_b32 v204, 16, v194
    v_and_b32 v205, s22, v194
    v_mfma_f32_32x32x16_bf16 v[128:143], a[100:103], v[164:167], v[128:143]
    ds_read_b128 v[164:167], v241 offset:0
    buffer_load_dwordx4 a[184:187], v254, s[4:7], s20 offen offset:2048 sc1
    v_lshlrev_b32 v206, 16, v195
    v_and_b32 v207, s22, v195
    v_mul_f32 v200, v200, v112
    v_mfma_f32_32x32x16_bf16 v[128:143], a[104:107], v[168:171], v[128:143]
    ds_read_b128 v[168:171], v240 offset:16384
    v_mul_f32 v201, v201, v113
    v_mul_f32 v202, v202, v114
    v_mul_f32 v203, v203, v115
    v_mul_f32 v204, v204, v116
    v_mfma_f32_32x32x16_bf16 v[128:143], a[108:111], v[172:175], v[128:143]
    ds_read_b128 v[172:175], v241 offset:16384
    buffer_load_dwordx4 a[188:191], v254, s[4:7], s20 offen offset:3072 sc1
    s_add_u32 s20, s20, 4096
    v_mul_f32 v205, v205, v117
    v_mul_f32 v206, v206, v118
    s_waitcnt vmcnt(16) lgkmcnt(4)
    v_mfma_f32_32x32x16_bf16 v[128:143], a[112:115], v[176:179], v[128:143]
    ds_read_b128 v[176:179], v240 offset:32768
    v_mul_f32 v207, v207, v119
    v_cvt_pk_bf16_f32 v216, v200, v201
    v_cvt_pk_bf16_f32 v217, v202, v203
    v_mfma_f32_32x32x16_bf16 v[128:143], a[116:119], v[180:183], v[128:143]
    ds_read_b128 v[180:183], v241 offset:32768
    buffer_load_dwordx4 a[192:195], v254, s[4:7], s20 offen offset:0 sc1
    v_cvt_pk_bf16_f32 v218, v204, v205
    v_cvt_pk_bf16_f32 v219, v206, v207
    v_lshlrev_b32 v208, 16, v196
    v_mfma_f32_32x32x16_bf16 v[128:143], a[120:123], v[184:187], v[128:143]
    ds_read_b128 v[184:187], v240 offset:49152
    ds_write_b128 v250, v[216:219] offset:8192
    v_mfma_f32_32x32x16_bf16 v[128:143], a[124:127], v[188:191], v[128:143]
    ds_read_b128 v[188:191], v241 offset:49152
    buffer_load_dwordx4 a[196:199], v254, s[4:7], s20 offen offset:1024 sc1
    v_and_b32 v209, s22, v196
    v_lshlrev_b32 v210, 16, v197
    v_and_b32 v211, s22, v197
    s_waitcnt lgkmcnt(5)
    v_mfma_f32_32x32x16_bf16 v[144:159], a[0:3], v[160:163], 0
    ds_read_b128 v[160:163], v242 offset:0
    v_lshlrev_b32 v212, 16, v198
    v_and_b32 v213, s22, v198
    v_lshlrev_b32 v214, 16, v199
    v_mfma_f32_32x32x16_bf16 v[144:159], a[4:7], v[164:167], v[144:159]
    ds_read_b128 v[164:167], v243 offset:0
    buffer_load_dwordx4 a[200:203], v254, s[4:7], s20 offen offset:2048 sc1
    v_cvt_pk_bf16_f32 v128, v128, v129
    v_cvt_pk_bf16_f32 v129, v130, v131
    v_cvt_pk_bf16_f32 v130, v132, v133
    v_mfma_f32_32x32x16_bf16 v[144:159], a[8:11], v[168:171], v[144:159]
    ds_read_b128 v[168:171], v242 offset:16384
    v_cvt_pk_bf16_f32 v131, v134, v135
    ds_write_b128 v253, v[128:131] offset:0
    v_mfma_f32_32x32x16_bf16 v[144:159], a[12:15], v[172:175], v[144:159]
    ds_read_b128 v[172:175], v243 offset:16384
    buffer_load_dwordx4 a[204:207], v254, s[4:7], s20 offen offset:3072 sc1
    s_add_u32 s20, s20, 4096
    v_cvt_pk_bf16_f32 v136, v136, v137
    v_cvt_pk_bf16_f32 v137, v138, v139
    s_waitcnt lgkmcnt(5)
    v_mfma_f32_32x32x16_bf16 v[144:159], a[16:19], v[176:179], v[144:159]
    ds_read_b128 v[176:179], v242 offset:32768
    v_cvt_pk_bf16_f32 v138, v140, v141
    v_cvt_pk_bf16_f32 v139, v142, v143
    v_and_b32 v215, s22, v199
    v_mfma_f32_32x32x16_bf16 v[144:159], a[20:23], v[180:183], v[144:159]
    ds_read_b128 v[180:183], v243 offset:32768
    buffer_load_dwordx4 a[208:211], v254, s[4:7], s20 offen offset:0 sc1
    ds_write_b128 v253, v[136:139] offset:1024
    v_mfma_f32_32x32x16_bf16 v[144:159], a[24:27], v[184:187], v[144:159]
    ds_read_b128 v[184:187], v242 offset:49152
    v_mul_f32 v208, v208, v120
    v_mul_f32 v209, v209, v121
    v_mul_f32 v210, v210, v122
    v_mul_f32 v211, v211, v123
    v_mfma_f32_32x32x16_bf16 v[144:159], a[28:31], v[188:191], v[144:159]
    ds_read_b128 v[188:191], v243 offset:49152
    buffer_load_dwordx4 a[212:215], v254, s[4:7], s20 offen offset:1024 sc1
    v_mul_f32 v212, v212, v124
    s_barrier
    s_waitcnt lgkmcnt(5)
    v_mfma_f32_32x32x16_bf16 v[144:159], a[32:35], v[160:163], v[144:159]
    ds_read_b128 v[160:163], v240 offset:8192
    v_mul_f32 v213, v213, v125
    v_mul_f32 v214, v214, v126
    v_mul_f32 v215, v215, v127
    v_mfma_f32_32x32x16_bf16 v[144:159], a[36:39], v[164:167], v[144:159]
    ds_read_b128 v[164:167], v241 offset:8192
    buffer_load_dwordx4 a[216:219], v254, s[4:7], s20 offen offset:2048 sc1
    v_cvt_pk_bf16_f32 v220, v208, v209
    v_cvt_pk_bf16_f32 v221, v210, v211
    v_cvt_pk_bf16_f32 v222, v212, v213
    v_mfma_f32_32x32x16_bf16 v[144:159], a[40:43], v[168:171], v[144:159]
    ds_read_b128 v[168:171], v240 offset:24576
    v_cvt_pk_bf16_f32 v223, v214, v215
    ds_write_b128 v251, v[220:223] offset:8192
    v_mfma_f32_32x32x16_bf16 v[144:159], a[44:47], v[172:175], v[144:159]
    ds_read_b128 v[172:175], v241 offset:24576
    buffer_load_dwordx4 a[220:223], v254, s[4:7], s20 offen offset:3072 sc1
    s_add_u32 s20, s20, 4096
    ds_read_u16 v224, v255 offset:0
    ds_read_u16 v226, v255 offset:64
    s_waitcnt lgkmcnt(7)
    v_mfma_f32_32x32x16_bf16 v[144:159], a[48:51], v[176:179], v[144:159]
    ds_read_b128 v[176:179], v240 offset:40960
    ds_read_u16 v228, v255 offset:128
    ds_read_u16 v230, v255 offset:192
    v_add_u32 v255, 1024, v255
    v_mfma_f32_32x32x16_bf16 v[144:159], a[52:55], v[180:183], v[144:159]
    ds_read_b128 v[180:183], v241 offset:40960
    buffer_load_dwordx4 a[224:227], v254, s[4:7], s20 offen offset:0 sc1
    ds_read_b128 v[192:195], v244 offset:4096
    ds_read_b128 v[196:199], v245 offset:4096
    v_mfma_f32_32x32x16_bf16 v[144:159], a[56:59], v[184:187], v[144:159]
    ds_read_b128 v[184:187], v240 offset:57344
    v_mfma_f32_32x32x16_bf16 v[144:159], a[60:63], v[188:191], v[144:159]
    ds_read_b128 v[188:191], v241 offset:57344
    buffer_load_dwordx4 a[228:231], v254, s[4:7], s20 offen offset:1024 sc1
    s_waitcnt lgkmcnt(3)
    v_lshlrev_b32 v128, 16, v192
    s_barrier
    v_mfma_f32_32x32x16_bf16 v[144:159], a[64:67], v[160:163], v[144:159]
    ds_read_b128 v[160:163], v242 offset:8192
    v_and_b32 v129, s22, v192
    v_lshlrev_b32 v130, 16, v193
    v_and_b32 v131, s22, v193
    v_lshlrev_b32 v132, 16, v194
    v_mfma_f32_32x32x16_bf16 v[144:159], a[68:71], v[164:167], v[144:159]
    ds_read_b128 v[164:167], v243 offset:8192
    buffer_load_dwordx4 a[232:235], v254, s[4:7], s20 offen offset:2048 sc1
    v_and_b32 v133, s22, v194
    v_lshlrev_b32 v134, 16, v195
    v_and_b32 v135, s22, v195
    v_mfma_f32_32x32x16_bf16 v[144:159], a[72:75], v[168:171], v[144:159]
    ds_read_b128 v[168:171], v242 offset:24576
    ds_read_b128 v[192:195], v246 offset:4096
    s_waitcnt lgkmcnt(6)
    v_lshlrev_b32 v136, 16, v196
    v_and_b32 v137, s22, v196
    v_mfma_f32_32x32x16_bf16 v[144:159], a[76:79], v[172:175], v[144:159]
    ds_read_b128 v[172:175], v243 offset:24576
    buffer_load_dwordx4 a[236:239], v254, s[4:7], s20 offen offset:3072 sc1
    s_add_u32 s20, s20, 4096
    v_lshlrev_b32 v138, 16, v197
    v_and_b32 v139, s22, v197
    s_waitcnt lgkmcnt(5)
    v_mfma_f32_32x32x16_bf16 v[144:159], a[80:83], v[176:179], v[144:159]
    ds_read_b128 v[176:179], v242 offset:40960
    v_lshlrev_b32 v140, 16, v198
    v_and_b32 v141, s22, v198
    v_lshlrev_b32 v142, 16, v199
    v_mfma_f32_32x32x16_bf16 v[144:159], a[84:87], v[180:183], v[144:159]
    ds_read_b128 v[180:183], v243 offset:40960
    buffer_load_dwordx4 a[240:243], v254, s[4:7], s20 offen offset:0 sc1
    v_and_b32 v143, s22, v199
    ds_read_b128 v[196:199], v247 offset:4096
    s_waitcnt lgkmcnt(4)
    v_lshlrev_b32 v200, 16, v192
    v_mfma_f32_32x32x16_bf16 v[144:159], a[88:91], v[184:187], v[144:159]
    ds_read_b128 v[184:187], v242 offset:57344
    v_and_b32 v201, s22, v192
    v_lshlrev_b32 v202, 16, v193
    v_and_b32 v203, s22, v193
    v_lshlrev_b32 v204, 16, v194
    v_mfma_f32_32x32x16_bf16 v[144:159], a[92:95], v[188:191], v[144:159]
    ds_read_b128 v[188:191], v243 offset:57344
    buffer_load_dwordx4 a[244:247], v254, s[4:7], s20 offen offset:1024 sc1
    v_and_b32 v205, s22, v194
    v_lshlrev_b32 v206, 16, v195
    v_and_b32 v207, s22, v195
    s_waitcnt lgkmcnt(5)
    v_mfma_f32_32x32x16_bf16 v[144:159], a[96:99], v[160:163], v[144:159]
    ds_read_b128 v[160:163], v252 offset:0
    s_waitcnt lgkmcnt(3)
    v_lshlrev_b32 v208, 16, v196
    v_and_b32 v209, s22, v196
    v_mfma_f32_32x32x16_bf16 v[144:159], a[100:103], v[164:167], v[144:159]
    ds_read_b128 v[164:167], v252 offset:1024
    buffer_load_dwordx4 a[248:251], v254, s[4:7], s20 offen offset:2048 sc1
    v_lshlrev_b32 v210, 16, v197
    v_and_b32 v211, s22, v197
    v_lshlrev_b32 v212, 16, v198
    v_mfma_f32_32x32x16_bf16 v[144:159], a[104:107], v[168:171], v[144:159]
    ds_read_b128 v[168:171], v252 offset:2048
    v_and_b32 v213, s22, v198
    v_lshlrev_b32 v214, 16, v199
    v_and_b32 v215, s22, v199
    v_mfma_f32_32x32x16_bf16 v[144:159], a[108:111], v[172:175], v[144:159]
    ds_read_b128 v[172:175], v252 offset:3072
    buffer_load_dwordx4 a[252:255], v254, s[4:7], s20 offen offset:3072 sc1
    s_add_u32 s20, s20, 200704
    s_waitcnt lgkmcnt(4)
    v_mfma_f32_32x32x16_bf16 v[144:159], a[112:115], v[176:179], v[144:159]
    ds_read_b128 v[176:179], v252 offset:4096
    v_mfma_f32_32x32x16_bf16 v[144:159], a[116:119], v[180:183], v[144:159]
    ds_read_b128 v[180:183], v252 offset:5120
    v_mfma_f32_32x32x16_bf16 v[144:159], a[120:123], v[184:187], v[144:159]
    ds_read_b128 v[184:187], v252 offset:6144
    v_mfma_f32_32x32x16_bf16 v[144:159], a[124:127], v[188:191], v[144:159]
    ds_read_b128 v[188:191], v252 offset:7168
    s_branch L_loop
L_epi:
    v_lshrrev_b32 v228, 4, v254
    v_lshrrev_b32 v229, 3, v228
    v_lshrrev_b32 v230, 4, v228
    v_and_b32 v231, 1, v229
    v_lshlrev_b32 v231, 2, v231
    v_or_b32 v230, v230, v231
    v_and_b32 v231, 7, v228
    v_xor_b32 v230, v230, v231
    v_lshlrev_b32 v230, 4, v230
    v_lshlrev_b32 v229, 10, v229
    v_add_u32 v226, v229, v230
    v_xor_b32 v227, 64, v226
    v_add_u32 v224, s28, v254
    v_add_u32 v225, 0x10000, v224
    s_waitcnt lgkmcnt(0)
    ds_read_b128 v[160:163], v224 offset:0
    ds_read_b128 v[164:167], v224 offset:1024
    ds_read_b128 v[168:171], v224 offset:2048
    ds_read_b128 v[172:175], v224 offset:3072
    ds_read_b128 v[176:179], v224 offset:8192
    ds_read_b128 v[180:183], v224 offset:9216
    ds_read_b128 v[184:187], v224 offset:10240
    ds_read_b128 v[188:191], v224 offset:11264
    s_add_u32 s43, s25, 0
    s_waitcnt lgkmcnt(7)
    buffer_store_dwordx4 v[160:163], v226, s[12:15], s43 offen nt
    s_addk_i32 s43, 8192
    s_waitcnt lgkmcnt(6)
    buffer_store_dwordx4 v[164:167], v226, s[12:15], s43 offen nt
    s_addk_i32 s43, 8192
    s_waitcnt lgkmcnt(5)
    buffer_store_dwordx4 v[168:171], v227, s[12:15], s43 offen nt
    s_addk_i32 s43, 8192
    s_waitcnt lgkmcnt(4)
    buffer_store_dwordx4 v[172:175], v227, s[12:15], s43 offen nt
    s_addk_i32 s43, -24448
    s_waitcnt lgkmcnt(3)
    buffer_store_dwordx4 v[176:179], v226, s[12:15], s43 offen nt
    s_addk_i32 s43, 8192
    s_waitcnt lgkmcnt(2)
    buffer_store_dwordx4 v[180:183], v226, s[12:15], s43 offen nt
    s_addk_i32 s43, 8192
    s_waitcnt lgkmcnt(1)
    buffer_store_dwordx4 v[184:187], v227, s[12:15], s43 offen nt
    s_addk_i32 s43, 8192
    s_waitcnt lgkmcnt(0)
    buffer_store_dwordx4 v[188:191], v227, s[12:15], s43 offen nt
    v_and_b32 v157, s22, v198
    v_lshlrev_b32 v158, 16, v199
    v_and_b32 v159, s22, v199
    ds_read_b128 v[196:199], v249 offset:12288
    v_mul_f32 v152, v152, v88
    v_mul_f32 v153, v153, v89
    v_mul_f32 v154, v154, v90
    v_mul_f32 v155, v155, v91
    v_mul_f32 v156, v156, v92
    v_mul_f32 v157, v157, v93
    v_mul_f32 v158, v158, v94
    v_mul_f32 v159, v159, v95
    v_cvt_pk_bf16_f32 v220, v152, v153
    v_cvt_pk_bf16_f32 v221, v154, v155
    v_cvt_pk_bf16_f32 v222, v156, v157
    v_cvt_pk_bf16_f32 v223, v158, v159
    ds_write_b128 v251, v[220:223] offset:0
    ds_read_b128 v[0:3], v225 offset:0
    ds_read_b128 v[4:7], v225 offset:1024
    ds_read_b128 v[8:11], v225 offset:2048
    ds_read_b128 v[12:15], v225 offset:3072
    s_addk_i32 s43, 8064
    s_waitcnt lgkmcnt(3)
    buffer_store_dwordx4 v[0:3], v226, s[12:15], s43 offen nt
    s_addk_i32 s43, 8192
    s_waitcnt lgkmcnt(2)
    buffer_store_dwordx4 v[4:7], v226, s[12:15], s43 offen nt
    s_addk_i32 s43, 8192
    s_waitcnt lgkmcnt(1)
    buffer_store_dwordx4 v[8:11], v227, s[12:15], s43 offen nt
    s_addk_i32 s43, 8192
    s_waitcnt lgkmcnt(0)
    buffer_store_dwordx4 v[12:15], v227, s[12:15], s43 offen nt
    v_lshlrev_b32 v200, 16, v192
    v_and_b32 v201, s22, v192
    v_lshlrev_b32 v202, 16, v193
    v_and_b32 v203, s22, v193
    v_lshlrev_b32 v204, 16, v194
    v_and_b32 v205, s22, v194
    v_lshlrev_b32 v206, 16, v195
    v_and_b32 v207, s22, v195
    ds_read_b128 v[192:195], v250 offset:12288
    v_mul_f32 v200, v200, v96
    v_mul_f32 v201, v201, v97
    v_mul_f32 v202, v202, v98
    v_mul_f32 v203, v203, v99
    v_mul_f32 v204, v204, v100
    v_mul_f32 v205, v205, v101
    v_mul_f32 v206, v206, v102
    v_mul_f32 v207, v207, v103
    v_cvt_pk_bf16_f32 v216, v200, v201
    v_cvt_pk_bf16_f32 v217, v202, v203
    v_cvt_pk_bf16_f32 v218, v204, v205
    v_cvt_pk_bf16_f32 v219, v206, v207
    ds_write_b128 v248, v[216:219] offset:8192
    v_lshlrev_b32 v208, 16, v196
    v_and_b32 v209, s22, v196
    v_lshlrev_b32 v210, 16, v197
    v_and_b32 v211, s22, v197
    v_lshlrev_b32 v212, 16, v198
    v_and_b32 v213, s22, v198
    v_lshlrev_b32 v214, 16, v199
    v_and_b32 v215, s22, v199
    ds_read_b128 v[196:199], v251 offset:12288
    v_mul_f32 v208, v208, v104
    v_mul_f32 v209, v209, v105
    v_mul_f32 v210, v210, v106
    v_mul_f32 v211, v211, v107
    v_mul_f32 v212, v212, v108
    v_mul_f32 v213, v213, v109
    v_mul_f32 v214, v214, v110
    v_mul_f32 v215, v215, v111
    v_cvt_pk_bf16_f32 v220, v208, v209
    v_cvt_pk_bf16_f32 v221, v210, v211
    v_cvt_pk_bf16_f32 v222, v212, v213
    v_cvt_pk_bf16_f32 v223, v214, v215
    ds_write_b128 v249, v[220:223] offset:8192
    s_waitcnt lgkmcnt(3)
    v_lshlrev_b32 v200, 16, v192
    v_and_b32 v201, s22, v192
    v_lshlrev_b32 v202, 16, v193
    v_and_b32 v203, s22, v193
    v_lshlrev_b32 v204, 16, v194
    v_and_b32 v205, s22, v194
    v_lshlrev_b32 v206, 16, v195
    v_and_b32 v207, s22, v195
    v_mul_f32 v200, v200, v112
    v_mul_f32 v201, v201, v113
    v_mul_f32 v202, v202, v114
    v_mul_f32 v203, v203, v115
    v_mul_f32 v204, v204, v116
    v_mul_f32 v205, v205, v117
    v_mul_f32 v206, v206, v118
    v_mul_f32 v207, v207, v119
    v_cvt_pk_bf16_f32 v216, v200, v201
    v_cvt_pk_bf16_f32 v217, v202, v203
    v_cvt_pk_bf16_f32 v218, v204, v205
    v_cvt_pk_bf16_f32 v219, v206, v207
    ds_write_b128 v250, v[216:219] offset:8192
    s_waitcnt lgkmcnt(2)
    v_lshlrev_b32 v208, 16, v196
    v_and_b32 v209, s22, v196
    v_lshlrev_b32 v210, 16, v197
    v_and_b32 v211, s22, v197
    v_lshlrev_b32 v212, 16, v198
    v_and_b32 v213, s22, v198
    v_lshlrev_b32 v214, 16, v199
    v_and_b32 v215, s22, v199
    v_mul_f32 v208, v208, v120
    v_mul_f32 v209, v209, v121
    v_mul_f32 v210, v210, v122
    v_mul_f32 v211, v211, v123
    v_mul_f32 v212, v212, v124
    v_mul_f32 v213, v213, v125
    v_mul_f32 v214, v214, v126
    v_mul_f32 v215, v215, v127
    v_cvt_pk_bf16_f32 v220, v208, v209
    v_cvt_pk_bf16_f32 v221, v210, v211
    v_cvt_pk_bf16_f32 v222, v212, v213
    v_cvt_pk_bf16_f32 v223, v214, v215
    ds_write_b128 v251, v[220:223] offset:8192
    ds_read_b128 v[16:19], v225 offset:8192
    ds_read_b128 v[20:23], v225 offset:9216
    ds_read_b128 v[24:27], v225 offset:10240
    ds_read_b128 v[28:31], v225 offset:11264
    s_addk_i32 s43, -24448
    s_waitcnt lgkmcnt(3)
    buffer_store_dwordx4 v[16:19], v226, s[12:15], s43 offen nt
    s_addk_i32 s43, 8192
    s_waitcnt lgkmcnt(2)
    buffer_store_dwordx4 v[20:23], v226, s[12:15], s43 offen nt
    s_addk_i32 s43, 8192
    s_waitcnt lgkmcnt(1)
    buffer_store_dwordx4 v[24:27], v227, s[12:15], s43 offen nt
    s_addk_i32 s43, 8192
    s_waitcnt lgkmcnt(0)
    buffer_store_dwordx4 v[28:31], v227, s[12:15], s43 offen nt
L_done:
    s_endpgm
.section .rodata,"a"
.p2align 6
.amdhsa_kernel standalone__cross_network_dcn_v2__recsys_kernel
  .amdhsa_next_free_vgpr 512
  .amdhsa_next_free_sgpr 102
  .amdhsa_accum_offset 256
  .amdhsa_group_segment_fixed_size 0
  .amdhsa_kernarg_size 56
  .amdhsa_user_sgpr_count 2
  .amdhsa_user_sgpr_kernarg_segment_ptr 1
  .amdhsa_system_sgpr_workgroup_id_x 1
  .amdhsa_float_denorm_mode_32 3
.end_amdhsa_kernel
```
